```python
import torch

def _softmax(x, axis=-1):
    return torch.softmax(x, dim=axis)
def _gelu(x):
    return torch.nn.functional.gelu(x, approximate="tanh")
def _silu(x):
    return torch.nn.functional.silu(x)
def _sigmoid(x):
    return torch.sigmoid(x)
def _layernorm(x, axis=-1, eps=1e-5):
    m = x.mean(dim=axis, keepdim=True)
    v = x.var(dim=axis, keepdim=True, unbiased=False)
    return (x - m) / torch.sqrt(v + eps)
def _scatter_add(tgt, idx, src, axis=0):
    return tgt.clone().index_add_(axis, idx, src)
def _segment_sum(src, seg, n):
    out = torch.zeros((n,) + src.shape[1:], dtype=src.dtype)
    return out.index_add_(0, seg, src)
def _pad(x, pw):
    flat = tuple(v for pair in reversed(pw) for v in pair)
    return torch.nn.functional.pad(x, flat)

kernel_name = 'concat_heads__mha_block__mha_block__prompt'

def setup_inputs():

    _w = (lambda a: (lambda t: t.to(torch.bfloat16) if t.is_floating_point() else t)(torch.as_tensor(a)))
    def _A_setup():
        B, S, D, H = 1, 2048, 512, 32
        return {
            "x": _w((lambda *s: torch.randn(*s, dtype=torch.bfloat16) * 0.2)(B, S, D)),
            "wqkv": _w((lambda *s: torch.randn(*s, dtype=torch.bfloat16) * 0.2)(D, 3 * D)),
            "wo": _w((lambda *s: torch.randn(*s, dtype=torch.bfloat16) * 0.05)(D, D)),
        }
    _A_in = _A_setup()

    def _B_setup():
        B, S, D, H = 1, 2048, 512, 32
        return {
            "x": _w((lambda *s: torch.randn(*s, dtype=torch.bfloat16) * 0.2)(B, S, D)),
            "wqkv": _w((lambda *s: torch.randn(*s, dtype=torch.bfloat16) * 0.2)(D, 3 * D)),
            "wo": _w((lambda *s: torch.randn(*s, dtype=torch.bfloat16) * 0.05)(D, D)),
        }
    _B_in = _B_setup()

    return {
        "A_x": _A_in["x"],
        "A_wqkv": _A_in["wqkv"],
        "A_wo": _A_in["wo"],
        "B_x": _B_in["x"],
        "B_wqkv": _B_in["wqkv"],
        "B_wo": _B_in["wo"],
    }

def reference(A_x, A_wqkv, A_wo, B_x, B_wqkv, B_wo):
    def _A_ref(x, wqkv, wo):
        B, S, D = x.shape
        H = 32
        Dh = D // H
        qkv = (lambda x, *d: x.permute(*d))((x @ wqkv).reshape(B, S, 3, H, Dh), 2, 0, 3, 1, 4)
        q, k, v = qkv[0], qkv[1], qkv[2]
        scores = torch.einsum("bhqd,bhkd->bhqk", q, k) * (Dh ** -0.5)
        p = _softmax(scores, axis=-1)
        o = torch.einsum("bhqk,bhkd->bhqd", p, v)
        return (lambda x, *d: x.permute(*d))(o, 0, 2, 1, 3).reshape(B, S, D) @ wo

    def _B_ref(x, wqkv, wo):
        B, S, D = x.shape
        H = 32
        Dh = D // H
        qkv = (lambda x, *d: x.permute(*d))((x @ wqkv).reshape(B, S, 3, H, Dh), 2, 0, 3, 1, 4)
        q, k, v = qkv[0], qkv[1], qkv[2]
        scores = torch.einsum("bhqd,bhkd->bhqk", q, k) * (Dh ** -0.5)
        p = _softmax(scores, axis=-1)
        o = torch.einsum("bhqk,bhkd->bhqd", p, v)
        return (lambda x, *d: x.permute(*d))(o, 0, 2, 1, 3).reshape(B, S, D) @ wo

    a = _A_ref(A_x, A_wqkv, A_wo)
    b = _B_ref(B_x, B_wqkv, B_wo)
    return torch.concatenate([a, b], axis=-1)
```

```asm
; @launch grid=(256,1,1) block=(1024,1,1) lds=163840
.amdgcn_target "amdgcn-amd-amdhsa--gfx950"
.text
.globl concat_heads__mha_block__mha_block__prompt_kernel
.p2align 8
.type concat_heads__mha_block__mha_block__prompt_kernel,@function
concat_heads__mha_block__mha_block__prompt_kernel:
    s_cmp_ge_u32 s2, 256
    s_cbranch_scc1 L_done
    s_load_dwordx16 s[4:19], s[0:1], 0
    s_load_dwordx2 s[20:21], s[0:1], 64
    s_memrealtime s[48:49]
    s_and_b32 s52, s2, 7
    s_lshr_b32 s53, s2, 3
    s_lshr_b32 s22, s52, 2
    s_and_b32 s23, s53, 15
    s_and_b32 s24, s52, 3
    s_lshl_b32 s24, s24, 1
    s_lshr_b32 s53, s53, 4
    s_add_u32 s24, s24, s53
    v_lshrrev_b32 v1, 6, v0
    v_and_b32 v0, 63, v0
    s_getreg_b32 s26, hwreg(HW_REG_XCC_ID)
    v_readfirstlane_b32 s25, v1
    s_and_b32 s26, s26, 7
    s_lshl_b32 s62, s25, 10
    s_waitcnt lgkmcnt(0)
    s_cmp_eq_u32 s22, 0
    s_cselect_b32 s4, s4, s10
    s_cselect_b32 s5, s5, s11
    s_cselect_b32 s6, s6, s12
    s_cselect_b32 s7, s7, s13
    s_cselect_b32 s8, s8, s14
    s_cselect_b32 s9, s9, s15
    s_lshl_b32 s52, s24, 18
    s_add_u32 s28, s4, s52
    s_addc_u32 s29, s5, 0
    s_and_b32 s29, s29, 0xffff
    s_mov_b32 s30, 262144
    s_mov_b32 s31, 0x20000
    s_mov_b32 s32, s6
    s_and_b32 s33, s7, 0xffff
    s_mov_b32 s34, 1572864
    s_mov_b32 s35, 0x20000
    s_cmp_ge_u32 s25, 8
    s_cbranch_scc1 L_loader
    s_and_b32 s53, s25, 6
    s_mov_b32 s52, s23
    s_cmp_eq_u32 s53, 0
    s_cbranch_scc1 L_tx_own
    s_cmp_lg_u32 s53, 6
    s_cbranch_scc1 L_tx_done
    s_sub_u32 s52, s23, 2
    s_lshr_b32 s53, s52, 1
    s_cmp_lg_u32 s53, 3
    s_cbranch_scc1 L_tx_done
    s_branch L_tx_go
L_tx_own:
    s_lshr_b32 s53, s52, 1
    s_cmp_eq_u32 s53, 3
    s_cbranch_scc1 L_tx_done
L_tx_go:
    s_lshl_b32 s52, s52, 14
    s_and_b32 s53, s25, 1
    s_lshl_b32 s53, s53, 13
    s_add_u32 s52, s52, s53
    v_lshlrev_b32 v13, 7, v0
    buffer_load_dword v125, v13, s[28:31], s52 offen
L_tx_done:
    s_sub_u32 s52, s25, 2
    s_cmp_ge_u32 s52, 2
    s_cbranch_scc1 L_tw_done
    s_lshl_b32 s53, s24, 4
    s_add_u32 s53, s53, s23
    s_lshl_b32 s53, s53, 1
    s_add_u32 s52, s52, s53
    s_mul_i32 s52, s52, 6144
    v_cmp_gt_u32 vcc, 48, v0
    v_lshlrev_b32 v13, 7, v0
    s_and_saveexec_b64 s[56:57], vcc
    buffer_load_dword v125, v13, s[32:35], s52 offen
    s_mov_b64 exec, -1
L_tw_done:
    s_branch L_compute
L_loader:
    s_sub_u32 s52, s25, 8
    s_and_b32 s53, s52, 1
    s_lshl_b32 s53, s53, 2
    v_lshrrev_b32 v2, 4, v0
    v_add_u32 v2, s53, v2
    v_and_b32 v3, 7, v0
    v_xor_b32 v2, v2, v3
    v_lshlrev_b32 v2, 4, v2
    v_lshrrev_b32 v4, 3, v0
    v_lshl_add_u32 v2, v4, 10, v2
    v_lshrrev_b32 v4, 2, v0
    v_mul_u32_u24 v4, 3072, v4
    v_and_b32 v3, 3, v0
    v_lshrrev_b32 v5, 5, v0
    v_lshlrev_b32 v5, 1, v5
    v_xor_b32 v3, v3, v5
    v_lshl_add_u32 v3, v3, 4, v4
    s_lshl_b32 s53, s23, 6
    v_add_u32 v3, s53, v3
    s_lshl_b32 s4, s52, 13
    s_add_u32 s5, s4, 65536
    s_add_u32 s6, s4, 131072
    s_add_u32 s7, s4, 196608
    s_lshl_b32 s0, s52, 10
    s_and_b32 s53, s52, 3
    s_mul_i32 s1, s53, 49152
    s_lshr_b32 s53, s52, 2
    s_lshl_b32 s53, s53, 10
    s_add_u32 s1, s1, s53
    s_and_b32 s3, s24, 6
    s_bitcmp1_b32 s24, 0
    s_mov_b32 s27, 0x47653210
    s_cselect_b32 s27, 0x76504321, s27
    s_bfe_u32 s53, s27, 0x40000
    s_add_u32 s53, s53, s3
    s_and_b32 s53, s53, 7
    s_lshl_b32 s57, s53, 7
    s_mul_i32 s53, s53, 196608
    s_add_u32 s53, s53, s1
    s_add_u32 m0, s0, 98304
    s_nop 0
    buffer_load_dwordx4 v3, s[32:35], s53 offen lds
    s_cmp_ge_u32 s52, 4
    s_cbranch_scc1 L_w1_0
    s_add_u32 m0, s0, 104448
    s_nop 0
    buffer_load_dwordx4 v3, s[32:35], s53 offen offset:2048 lds
L_w1_0:
    s_add_u32 m0, s0, 0
    s_add_u32 s53, s4, s57
    buffer_load_dwordx4 v2, s[28:31], s53 offen lds
    s_add_u32 m0, s0, 8192
    s_add_u32 s53, s5, s57
    buffer_load_dwordx4 v2, s[28:31], s53 offen lds
    s_add_u32 m0, s0, 16384
    s_add_u32 s53, s6, s57
    buffer_load_dwordx4 v2, s[28:31], s53 offen lds
    s_add_u32 m0, s0, 24576
    s_add_u32 s53, s7, s57
    buffer_load_dwordx4 v2, s[28:31], s53 offen lds
    s_barrier
    s_bfe_u32 s53, s27, 0x40004
    s_add_u32 s53, s53, s3
    s_and_b32 s53, s53, 7
    s_lshl_b32 s57, s53, 7
    s_mul_i32 s53, s53, 196608
    s_add_u32 s53, s53, s1
    s_add_u32 m0, s0, 110592
    s_nop 0
    buffer_load_dwordx4 v3, s[32:35], s53 offen lds
    s_cmp_ge_u32 s52, 4
    s_cbranch_scc1 L_w1_1
    s_add_u32 m0, s0, 116736
    s_nop 0
    buffer_load_dwordx4 v3, s[32:35], s53 offen offset:2048 lds
L_w1_1:
    s_add_u32 m0, s0, 32768
    s_add_u32 s53, s4, s57
    buffer_load_dwordx4 v2, s[28:31], s53 offen lds
    s_add_u32 m0, s0, 40960
    s_add_u32 s53, s5, s57
    buffer_load_dwordx4 v2, s[28:31], s53 offen lds
    s_add_u32 m0, s0, 49152
    s_add_u32 s53, s6, s57
    buffer_load_dwordx4 v2, s[28:31], s53 offen lds
    s_add_u32 m0, s0, 57344
    s_add_u32 s53, s7, s57
    buffer_load_dwordx4 v2, s[28:31], s53 offen lds
    s_cmp_ge_u32 s52, 4
    s_cbranch_scc1 L_loaderB
    s_mov_b32 s36, s20
    s_and_b32 s37, s21, 0xffff
    s_mov_b32 s38, 13631488
    s_mov_b32 s39, 0x20000
    s_and_b32 s52, s23, 7
    s_lshl_b32 s52, s52, 7
    s_add_u32 s40, s8, s52
    s_addc_u32 s41, s9, 0
    s_and_b32 s41, s41, 0xffff
    s_sub_u32 s42, 524288, s52
    s_mov_b32 s43, 0x20000
    s_mov_b32 s44, s16
    s_and_b32 s45, s17, 0xffff
    s_mov_b32 s46, 4194304
    s_mov_b32 s47, 0x20000
    s_mov_b32 s50, 0xffff
    s_mov_b32 s51, 0xffff
    s_lshl_b32 s54, s22, 4
    s_add_u32 s54, s54, s23
    s_lshl_b32 s54, s54, 18
    s_lshl_b32 s55, s24, 15
    s_add_u32 s55, s55, s54
    v_lshlrev_b32 v121, 4, v0
    s_lshr_b32 s56, s25, 3
    s_lshl_b32 s53, s56, 13
    v_add_u32 v117, s53, v121
    v_add_u32 v118, 0x10000, v117
    v_add_u32 v98, 0x20000, v117
    v_and_b32 v13, 15, v0
    v_lshlrev_b32 v13, 4, v13
    v_lshrrev_b32 v14, 5, v0
    v_lshl_add_u32 v13, v14, 8, v13
    s_add_u32 s53, s53, 1024
    v_add_u32 v119, s53, v13
    v_add_u32 v120, 0x10000, v119
    v_add_u32 v99, 0x20000, v119
    v_mov_b32 v116, 0xdddddddd
    v_and_b32 v13, 27, v0
    v_cmp_eq_u32 vcc, 16, v13
    v_mov_b32 v14, 0x3f803f80
    v_mov_b32 v122, 163832
    v_lshlrev_b32 v126, 3, v0
    v_cndmask_b32 v13, 0, v14, vcc
    v_mov_b32 v100, v13
    v_mov_b32 v101, v13
    v_mov_b32 v102, v13
    v_mov_b32 v103, v13
    v_mov_b32 v104, v13
    v_mov_b32 v105, v13
    v_mov_b32 v106, v13
    v_mov_b32 v107, v13
    v_mov_b32 v108, v13
    v_mov_b32 v109, v13
    v_mov_b32 v110, v13
    v_mov_b32 v111, v13
    v_mov_b32 v112, v13
    v_mov_b32 v113, v13
    v_mov_b32 v114, v13
    v_mov_b32 v115, v13
    s_and_b32 s53, s25, 7
    s_lshl_b32 s58, s24, 3
    s_add_u32 s58, s58, s53
    s_lshl_b32 s57, s22, 6
    s_add_u32 s58, s58, s57
    s_lshl_b32 s58, s58, 5
    s_lshl_b32 s53, s23, 1
    s_add_u32 s53, s53, s56
    s_add_u32 s58, s58, s53
    s_lshl_b32 s59, s58, 3
    s_add_u32 s59, s59, 12648448
    s_lshl_b32 s58, s58, 10
    s_add_u32 s58, s58, 8388608
    s_lshr_b32 s60, s54, 7
    s_add_u32 s60, s60, 12582912
    s_lshl_b32 s61, s24, 8
    s_add_u32 s61, s61, s60
    s_bfe_u32 s53, s25, 0x10002
    s_lshl_b32 s53, s53, 7
    s_add_u32 s61, s61, s53
    s_and_b32 s53, s25, 3
    s_lshl_b32 s53, s53, 3
    s_add_u32 s61, s61, s53
    s_lshl_b32 s10, s22, 3
    s_add_u32 s10, s10, s24
    s_lshl_b32 s10, s10, 7
    s_add_u32 s10, s10, 12713984
    s_lshl_b32 s52, s24, 3
    s_lshr_b32 s53, s23, 3
    s_lshl_b32 s53, s53, 2
    s_add_u32 s52, s52, s53
    s_add_u32 s53, s57, s52
    s_lshl_b32 s11, s53, 8
    s_add_u32 s11, s11, 12648448
    s_and_b32 s12, s25, 3
    s_add_u32 s52, s52, s12
    s_add_u32 s53, s53, s12
    s_lshl_b32 s12, s53, 15
    s_add_u32 s12, s12, 8388608
    s_lshl_b32 s13, s22, 10
    s_and_b32 s53, s23, 7
    s_lshl_b32 s53, s53, 7
    s_add_u32 s13, s13, s53
    s_lshl_b32 s53, s52, 16
    s_add_u32 s13, s13, s53
    s_waitcnt vmcnt(6)
    s_barrier
    s_bfe_u32 s53, s27, 0x40008
    s_add_u32 s53, s53, s3
    s_and_b32 s53, s53, 7
    s_lshl_b32 s57, s53, 7
    s_mul_i32 s53, s53, 196608
    s_add_u32 s53, s53, s1
    s_add_u32 m0, s0, 122880
    s_nop 0
    buffer_load_dwordx4 v3, s[32:35], s53 offen lds
    s_add_u32 m0, s0, 129024
    s_nop 0
    buffer_load_dwordx4 v3, s[32:35], s53 offen offset:2048 lds
    s_add_u32 m0, s0, 65536
    s_add_u32 s53, s4, s57
    buffer_load_dwordx4 v2, s[28:31], s53 offen lds
    s_add_u32 m0, s0, 73728
    s_add_u32 s53, s5, s57
    buffer_load_dwordx4 v2, s[28:31], s53 offen lds
    s_add_u32 m0, s0, 81920
    s_add_u32 s53, s6, s57
    buffer_load_dwordx4 v2, s[28:31], s53 offen lds
    s_add_u32 m0, s0, 90112
    s_add_u32 s53, s7, s57
    buffer_load_dwordx4 v2, s[28:31], s53 offen lds
    s_waitcnt vmcnt(6)
    s_barrier
    s_bfe_u32 s53, s27, 0x4000c
    s_add_u32 s53, s53, s3
    s_and_b32 s53, s53, 7
    s_lshl_b32 s57, s53, 7
    s_mul_i32 s53, s53, 196608
    s_add_u32 s53, s53, s1
    s_add_u32 m0, s0, 98304
    s_nop 0
    buffer_load_dwordx4 v3, s[32:35], s53 offen lds
    s_add_u32 m0, s0, 104448
    s_nop 0
    buffer_load_dwordx4 v3, s[32:35], s53 offen offset:2048 lds
    s_add_u32 m0, s0, 0
    s_add_u32 s53, s4, s57
    buffer_load_dwordx4 v2, s[28:31], s53 offen lds
    s_add_u32 m0, s0, 8192
    s_add_u32 s53, s5, s57
    buffer_load_dwordx4 v2, s[28:31], s53 offen lds
    s_add_u32 m0, s0, 16384
    s_add_u32 s53, s6, s57
    buffer_load_dwordx4 v2, s[28:31], s53 offen lds
    s_add_u32 m0, s0, 24576
    s_add_u32 s53, s7, s57
    buffer_load_dwordx4 v2, s[28:31], s53 offen lds
    s_waitcnt vmcnt(6)
    s_barrier
    s_bfe_u32 s53, s27, 0x40010
    s_add_u32 s53, s53, s3
    s_and_b32 s53, s53, 7
    s_lshl_b32 s57, s53, 7
    s_mul_i32 s53, s53, 196608
    s_add_u32 s53, s53, s1
    s_add_u32 m0, s0, 110592
    s_nop 0
    buffer_load_dwordx4 v3, s[32:35], s53 offen lds
    s_add_u32 m0, s0, 116736
    s_nop 0
    buffer_load_dwordx4 v3, s[32:35], s53 offen offset:2048 lds
    s_add_u32 m0, s0, 32768
    s_add_u32 s53, s4, s57
    buffer_load_dwordx4 v2, s[28:31], s53 offen lds
    s_add_u32 m0, s0, 40960
    s_add_u32 s53, s5, s57
    buffer_load_dwordx4 v2, s[28:31], s53 offen lds
    s_add_u32 m0, s0, 49152
    s_add_u32 s53, s6, s57
    buffer_load_dwordx4 v2, s[28:31], s53 offen lds
    s_add_u32 m0, s0, 57344
    s_add_u32 s53, s7, s57
    buffer_load_dwordx4 v2, s[28:31], s53 offen lds
    s_waitcnt vmcnt(6)
    s_barrier
    s_bfe_u32 s53, s27, 0x40014
    s_add_u32 s53, s53, s3
    s_and_b32 s53, s53, 7
    s_lshl_b32 s57, s53, 7
    s_mul_i32 s53, s53, 196608
    s_add_u32 s53, s53, s1
    s_add_u32 m0, s0, 122880
    s_nop 0
    buffer_load_dwordx4 v3, s[32:35], s53 offen lds
    s_add_u32 m0, s0, 129024
    s_nop 0
    buffer_load_dwordx4 v3, s[32:35], s53 offen offset:2048 lds
    s_add_u32 m0, s0, 65536
    s_add_u32 s53, s4, s57
    buffer_load_dwordx4 v2, s[28:31], s53 offen lds
    s_add_u32 m0, s0, 73728
    s_add_u32 s53, s5, s57
    buffer_load_dwordx4 v2, s[28:31], s53 offen lds
    s_add_u32 m0, s0, 81920
    s_add_u32 s53, s6, s57
    buffer_load_dwordx4 v2, s[28:31], s53 offen lds
    s_add_u32 m0, s0, 90112
    s_add_u32 s53, s7, s57
    buffer_load_dwordx4 v2, s[28:31], s53 offen lds
    s_waitcnt vmcnt(6)
    s_barrier
    s_bfe_u32 s53, s27, 0x40018
    s_add_u32 s53, s53, s3
    s_and_b32 s53, s53, 7
    s_lshl_b32 s57, s53, 7
    s_mul_i32 s53, s53, 196608
    s_add_u32 s53, s53, s1
    s_add_u32 m0, s0, 98304
    s_nop 0
    buffer_load_dwordx4 v3, s[32:35], s53 offen lds
    s_add_u32 m0, s0, 104448
    s_nop 0
    buffer_load_dwordx4 v3, s[32:35], s53 offen offset:2048 lds
    s_add_u32 m0, s0, 0
    s_add_u32 s53, s4, s57
    buffer_load_dwordx4 v2, s[28:31], s53 offen lds
    s_add_u32 m0, s0, 8192
    s_add_u32 s53, s5, s57
    buffer_load_dwordx4 v2, s[28:31], s53 offen lds
    s_add_u32 m0, s0, 16384
    s_add_u32 s53, s6, s57
    buffer_load_dwordx4 v2, s[28:31], s53 offen lds
    s_add_u32 m0, s0, 24576
    s_add_u32 s53, s7, s57
    buffer_load_dwordx4 v2, s[28:31], s53 offen lds
    s_waitcnt vmcnt(6)
    s_barrier
    s_bfe_u32 s53, s27, 0x4001c
    s_add_u32 s53, s53, s3
    s_and_b32 s53, s53, 7
    s_lshl_b32 s57, s53, 7
    s_mul_i32 s53, s53, 196608
    s_add_u32 s53, s53, s1
    s_add_u32 m0, s0, 110592
    s_nop 0
    buffer_load_dwordx4 v3, s[32:35], s53 offen lds
    s_add_u32 m0, s0, 116736
    s_nop 0
    buffer_load_dwordx4 v3, s[32:35], s53 offen offset:2048 lds
    s_add_u32 m0, s0, 32768
    s_add_u32 s53, s4, s57
    buffer_load_dwordx4 v2, s[28:31], s53 offen lds
    s_add_u32 m0, s0, 40960
    s_add_u32 s53, s5, s57
    buffer_load_dwordx4 v2, s[28:31], s53 offen lds
    s_add_u32 m0, s0, 49152
    s_add_u32 s53, s6, s57
    buffer_load_dwordx4 v2, s[28:31], s53 offen lds
    s_add_u32 m0, s0, 57344
    s_add_u32 s53, s7, s57
    buffer_load_dwordx4 v2, s[28:31], s53 offen lds
    s_waitcnt vmcnt(6)
    s_barrier
    s_waitcnt vmcnt(0)
    s_barrier
    s_branch L_p2_start
L_loaderB:
    s_cmp_lg_u32 s2, 0
    s_cbranch_scc1 L_notag
    s_cmp_lg_u32 s52, 7
    s_cbranch_scc1 L_notag
    s_lshl_b64 s[48:49], s[48:49], 4
    s_or_b32 s48, s48, 8
    v_mov_b32 v8, 0
    v_mov_b32 v4, s48
    v_mov_b32 v5, s49
    s_mov_b64 exec, 1
    global_store_dwordx2 v8, v[4:5], s[18:19] sc1
    s_mov_b64 exec, -1
L_notag:
    s_mov_b32 s36, s20
    s_and_b32 s37, s21, 0xffff
    s_mov_b32 s38, 13631488
    s_mov_b32 s39, 0x20000
    s_and_b32 s52, s23, 7
    s_lshl_b32 s52, s52, 7
    s_add_u32 s40, s8, s52
    s_addc_u32 s41, s9, 0
    s_and_b32 s41, s41, 0xffff
    s_sub_u32 s42, 524288, s52
    s_mov_b32 s43, 0x20000
    s_mov_b32 s44, s16
    s_and_b32 s45, s17, 0xffff
    s_mov_b32 s46, 4194304
    s_mov_b32 s47, 0x20000
    s_mov_b32 s50, 0xffff
    s_mov_b32 s51, 0xffff
    s_lshl_b32 s54, s22, 4
    s_add_u32 s54, s54, s23
    s_lshl_b32 s54, s54, 18
    s_lshl_b32 s55, s24, 15
    s_add_u32 s55, s55, s54
    v_lshlrev_b32 v121, 4, v0
    s_lshr_b32 s56, s25, 3
    s_lshl_b32 s53, s56, 13
    v_add_u32 v117, s53, v121
    v_add_u32 v118, 0x10000, v117
    v_add_u32 v98, 0x20000, v117
    v_and_b32 v13, 15, v0
    v_lshlrev_b32 v13, 4, v13
    v_lshrrev_b32 v14, 5, v0
    v_lshl_add_u32 v13, v14, 8, v13
    s_add_u32 s53, s53, 1024
    v_add_u32 v119, s53, v13
    v_add_u32 v120, 0x10000, v119
    v_add_u32 v99, 0x20000, v119
    v_mov_b32 v116, 0xdddddddd
    v_and_b32 v13, 27, v0
    v_cmp_eq_u32 vcc, 16, v13
    v_mov_b32 v14, 0x3f803f80
    v_mov_b32 v122, 163832
    v_lshlrev_b32 v126, 3, v0
    v_cndmask_b32 v13, 0, v14, vcc
    v_mov_b32 v100, v13
    v_mov_b32 v101, v13
    v_mov_b32 v102, v13
    v_mov_b32 v103, v13
    v_mov_b32 v104, v13
    v_mov_b32 v105, v13
    v_mov_b32 v106, v13
    v_mov_b32 v107, v13
    v_mov_b32 v108, v13
    v_mov_b32 v109, v13
    v_mov_b32 v110, v13
    v_mov_b32 v111, v13
    v_mov_b32 v112, v13
    v_mov_b32 v113, v13
    v_mov_b32 v114, v13
    v_mov_b32 v115, v13
    s_and_b32 s53, s25, 7
    s_lshl_b32 s58, s24, 3
    s_add_u32 s58, s58, s53
    s_lshl_b32 s57, s22, 6
    s_add_u32 s58, s58, s57
    s_lshl_b32 s58, s58, 5
    s_lshl_b32 s53, s23, 1
    s_add_u32 s53, s53, s56
    s_add_u32 s58, s58, s53
    s_lshl_b32 s59, s58, 3
    s_add_u32 s59, s59, 12648448
    s_lshl_b32 s58, s58, 10
    s_add_u32 s58, s58, 8388608
    s_lshr_b32 s60, s54, 7
    s_add_u32 s60, s60, 12582912
    s_lshl_b32 s61, s24, 8
    s_add_u32 s61, s61, s60
    s_bfe_u32 s53, s25, 0x10002
    s_lshl_b32 s53, s53, 7
    s_add_u32 s61, s61, s53
    s_and_b32 s53, s25, 3
    s_lshl_b32 s53, s53, 3
    s_add_u32 s61, s61, s53
    s_lshl_b32 s10, s22, 3
    s_add_u32 s10, s10, s24
    s_lshl_b32 s10, s10, 7
    s_add_u32 s10, s10, 12713984
    s_lshl_b32 s52, s24, 3
    s_lshr_b32 s53, s23, 3
    s_lshl_b32 s53, s53, 2
    s_add_u32 s52, s52, s53
    s_add_u32 s53, s57, s52
    s_lshl_b32 s11, s53, 8
    s_add_u32 s11, s11, 12648448
    s_and_b32 s12, s25, 3
    s_add_u32 s52, s52, s12
    s_add_u32 s53, s53, s12
    s_lshl_b32 s12, s53, 15
    s_add_u32 s12, s12, 8388608
    s_lshl_b32 s13, s22, 10
    s_and_b32 s53, s23, 7
    s_lshl_b32 s53, s53, 7
    s_add_u32 s13, s13, s53
    s_lshl_b32 s53, s52, 16
    s_add_u32 s13, s13, s53
    s_waitcnt vmcnt(5)
    s_barrier
    s_bfe_u32 s53, s27, 0x40008
    s_add_u32 s53, s53, s3
    s_and_b32 s53, s53, 7
    s_lshl_b32 s57, s53, 7
    s_mul_i32 s53, s53, 196608
    s_add_u32 s53, s53, s1
    s_add_u32 m0, s0, 122880
    s_nop 0
    buffer_load_dwordx4 v3, s[32:35], s53 offen lds
    s_add_u32 m0, s0, 65536
    s_add_u32 s53, s4, s57
    buffer_load_dwordx4 v2, s[28:31], s53 offen lds
    s_add_u32 m0, s0, 73728
    s_add_u32 s53, s5, s57
    buffer_load_dwordx4 v2, s[28:31], s53 offen lds
    s_add_u32 m0, s0, 81920
    s_add_u32 s53, s6, s57
    buffer_load_dwordx4 v2, s[28:31], s53 offen lds
    s_add_u32 m0, s0, 90112
    s_add_u32 s53, s7, s57
    buffer_load_dwordx4 v2, s[28:31], s53 offen lds
    s_waitcnt vmcnt(5)
    s_barrier
    s_bfe_u32 s53, s27, 0x4000c
    s_add_u32 s53, s53, s3
    s_and_b32 s53, s53, 7
    s_lshl_b32 s57, s53, 7
    s_mul_i32 s53, s53, 196608
    s_add_u32 s53, s53, s1
    s_add_u32 m0, s0, 98304
    s_nop 0
    buffer_load_dwordx4 v3, s[32:35], s53 offen lds
    s_add_u32 m0, s0, 0
    s_add_u32 s53, s4, s57
    buffer_load_dwordx4 v2, s[28:31], s53 offen lds
    s_add_u32 m0, s0, 8192
    s_add_u32 s53, s5, s57
    buffer_load_dwordx4 v2, s[28:31], s53 offen lds
    s_add_u32 m0, s0, 16384
    s_add_u32 s53, s6, s57
    buffer_load_dwordx4 v2, s[28:31], s53 offen lds
    s_add_u32 m0, s0, 24576
    s_add_u32 s53, s7, s57
    buffer_load_dwordx4 v2, s[28:31], s53 offen lds
    s_waitcnt vmcnt(5)
    s_barrier
    s_bfe_u32 s53, s27, 0x40010
    s_add_u32 s53, s53, s3
    s_and_b32 s53, s53, 7
    s_lshl_b32 s57, s53, 7
    s_mul_i32 s53, s53, 196608
    s_add_u32 s53, s53, s1
    s_add_u32 m0, s0, 110592
    s_nop 0
    buffer_load_dwordx4 v3, s[32:35], s53 offen lds
    s_add_u32 m0, s0, 32768
    s_add_u32 s53, s4, s57
    buffer_load_dwordx4 v2, s[28:31], s53 offen lds
    s_add_u32 m0, s0, 40960
    s_add_u32 s53, s5, s57
    buffer_load_dwordx4 v2, s[28:31], s53 offen lds
    s_add_u32 m0, s0, 49152
    s_add_u32 s53, s6, s57
    buffer_load_dwordx4 v2, s[28:31], s53 offen lds
    s_add_u32 m0, s0, 57344
    s_add_u32 s53, s7, s57
    buffer_load_dwordx4 v2, s[28:31], s53 offen lds
    s_waitcnt vmcnt(5)
    s_barrier
    s_bfe_u32 s53, s27, 0x40014
    s_add_u32 s53, s53, s3
    s_and_b32 s53, s53, 7
    s_lshl_b32 s57, s53, 7
    s_mul_i32 s53, s53, 196608
    s_add_u32 s53, s53, s1
    s_add_u32 m0, s0, 122880
    s_nop 0
    buffer_load_dwordx4 v3, s[32:35], s53 offen lds
    s_add_u32 m0, s0, 65536
    s_add_u32 s53, s4, s57
    buffer_load_dwordx4 v2, s[28:31], s53 offen lds
    s_add_u32 m0, s0, 73728
    s_add_u32 s53, s5, s57
    buffer_load_dwordx4 v2, s[28:31], s53 offen lds
    s_add_u32 m0, s0, 81920
    s_add_u32 s53, s6, s57
    buffer_load_dwordx4 v2, s[28:31], s53 offen lds
    s_add_u32 m0, s0, 90112
    s_add_u32 s53, s7, s57
    buffer_load_dwordx4 v2, s[28:31], s53 offen lds
    s_waitcnt vmcnt(5)
    s_barrier
    s_bfe_u32 s53, s27, 0x40018
    s_add_u32 s53, s53, s3
    s_and_b32 s53, s53, 7
    s_lshl_b32 s57, s53, 7
    s_mul_i32 s53, s53, 196608
    s_add_u32 s53, s53, s1
    s_add_u32 m0, s0, 98304
    s_nop 0
    buffer_load_dwordx4 v3, s[32:35], s53 offen lds
    s_add_u32 m0, s0, 0
    s_add_u32 s53, s4, s57
    buffer_load_dwordx4 v2, s[28:31], s53 offen lds
    s_add_u32 m0, s0, 8192
    s_add_u32 s53, s5, s57
    buffer_load_dwordx4 v2, s[28:31], s53 offen lds
    s_add_u32 m0, s0, 16384
    s_add_u32 s53, s6, s57
    buffer_load_dwordx4 v2, s[28:31], s53 offen lds
    s_add_u32 m0, s0, 24576
    s_add_u32 s53, s7, s57
    buffer_load_dwordx4 v2, s[28:31], s53 offen lds
    s_waitcnt vmcnt(5)
    s_barrier
    s_bfe_u32 s53, s27, 0x4001c
    s_add_u32 s53, s53, s3
    s_and_b32 s53, s53, 7
    s_lshl_b32 s57, s53, 7
    s_mul_i32 s53, s53, 196608
    s_add_u32 s53, s53, s1
    s_add_u32 m0, s0, 110592
    s_nop 0
    buffer_load_dwordx4 v3, s[32:35], s53 offen lds
    s_add_u32 m0, s0, 32768
    s_add_u32 s53, s4, s57
    buffer_load_dwordx4 v2, s[28:31], s53 offen lds
    s_add_u32 m0, s0, 40960
    s_add_u32 s53, s5, s57
    buffer_load_dwordx4 v2, s[28:31], s53 offen lds
    s_add_u32 m0, s0, 49152
    s_add_u32 s53, s6, s57
    buffer_load_dwordx4 v2, s[28:31], s53 offen lds
    s_add_u32 m0, s0, 57344
    s_add_u32 s53, s7, s57
    buffer_load_dwordx4 v2, s[28:31], s53 offen lds
    v_mov_b32 v8, 0
    global_load_dwordx2 v[6:7], v8, s[18:19] sc1
    s_waitcnt vmcnt(6)
    s_barrier
    s_mov_b32 s63, 262144
L_tag_chk:
    s_waitcnt vmcnt(0)
    v_cmp_ne_u64 vcc, 0, v[6:7]
    s_nop 1
    s_cmp_eq_u64 vcc, -1
    s_cbranch_scc1 L_tag_ok
    s_sleep 1
    global_load_dwordx2 v[6:7], v8, s[18:19] sc1
    s_sub_u32 s63, s63, 1
    s_cmp_lg_u32 s63, 0
    s_cbranch_scc1 L_tag_chk
    s_waitcnt vmcnt(0)
L_tag_ok:
    ds_write_b64 v122, v[6:7]
    s_barrier
    s_branch L_p2_start
L_compute:
    s_barrier
    s_mov_b32 s36, s20
    s_and_b32 s37, s21, 0xffff
    s_mov_b32 s38, 13631488
    s_mov_b32 s39, 0x20000
    s_and_b32 s52, s23, 7
    s_lshl_b32 s52, s52, 7
    s_add_u32 s40, s8, s52
    s_addc_u32 s41, s9, 0
    s_and_b32 s41, s41, 0xffff
    s_sub_u32 s42, 524288, s52
    s_mov_b32 s43, 0x20000
    s_mov_b32 s44, s16
    s_and_b32 s45, s17, 0xffff
    s_mov_b32 s46, 4194304
    s_mov_b32 s47, 0x20000
    s_mov_b32 s50, 0xffff
    s_mov_b32 s51, 0xffff
    s_lshl_b32 s54, s22, 4
    s_add_u32 s54, s54, s23
    s_lshl_b32 s54, s54, 18
    s_lshl_b32 s55, s24, 15
    s_add_u32 s55, s55, s54
    v_lshlrev_b32 v121, 4, v0
    s_lshr_b32 s56, s25, 3
    s_lshl_b32 s53, s56, 13
    v_add_u32 v117, s53, v121
    v_add_u32 v118, 0x10000, v117
    v_add_u32 v98, 0x20000, v117
    v_and_b32 v13, 15, v0
    v_lshlrev_b32 v13, 4, v13
    v_lshrrev_b32 v14, 5, v0
    v_lshl_add_u32 v13, v14, 8, v13
    s_add_u32 s53, s53, 1024
    v_add_u32 v119, s53, v13
    v_add_u32 v120, 0x10000, v119
    v_add_u32 v99, 0x20000, v119
    v_mov_b32 v116, 0xdddddddd
    v_and_b32 v13, 27, v0
    v_cmp_eq_u32 vcc, 16, v13
    v_mov_b32 v14, 0x3f803f80
    v_mov_b32 v122, 163832
    v_lshlrev_b32 v126, 3, v0
    v_cndmask_b32 v13, 0, v14, vcc
    v_mov_b32 v100, v13
    v_mov_b32 v101, v13
    v_mov_b32 v102, v13
    v_mov_b32 v103, v13
    v_mov_b32 v104, v13
    v_mov_b32 v105, v13
    v_mov_b32 v106, v13
    v_mov_b32 v107, v13
    v_mov_b32 v108, v13
    v_mov_b32 v109, v13
    v_mov_b32 v110, v13
    v_mov_b32 v111, v13
    v_mov_b32 v112, v13
    v_mov_b32 v113, v13
    v_mov_b32 v114, v13
    v_mov_b32 v115, v13
    s_and_b32 s53, s25, 7
    s_lshl_b32 s58, s24, 3
    s_add_u32 s58, s58, s53
    s_lshl_b32 s57, s22, 6
    s_add_u32 s58, s58, s57
    s_lshl_b32 s58, s58, 5
    s_lshl_b32 s53, s23, 1
    s_add_u32 s53, s53, s56
    s_add_u32 s58, s58, s53
    s_lshl_b32 s59, s58, 3
    s_add_u32 s59, s59, 12648448
    s_lshl_b32 s58, s58, 10
    s_add_u32 s58, s58, 8388608
    s_lshr_b32 s60, s54, 7
    s_add_u32 s60, s60, 12582912
    s_lshl_b32 s61, s24, 8
    s_add_u32 s61, s61, s60
    s_bfe_u32 s53, s25, 0x10002
    s_lshl_b32 s53, s53, 7
    s_add_u32 s61, s61, s53
    s_and_b32 s53, s25, 3
    s_lshl_b32 s53, s53, 3
    s_add_u32 s61, s61, s53
    s_lshl_b32 s10, s22, 3
    s_add_u32 s10, s10, s24
    s_lshl_b32 s10, s10, 7
    s_add_u32 s10, s10, 12713984
    s_lshl_b32 s52, s24, 3
    s_lshr_b32 s53, s23, 3
    s_lshl_b32 s53, s53, 2
    s_add_u32 s52, s52, s53
    s_add_u32 s53, s57, s52
    s_lshl_b32 s11, s53, 8
    s_add_u32 s11, s11, 12648448
    s_and_b32 s12, s25, 3
    s_add_u32 s52, s52, s12
    s_add_u32 s53, s53, s12
    s_lshl_b32 s12, s53, 15
    s_add_u32 s12, s12, 8388608
    s_lshl_b32 s13, s22, 10
    s_and_b32 s53, s23, 7
    s_lshl_b32 s53, s53, 7
    s_add_u32 s13, s13, s53
    s_lshl_b32 s53, s52, 16
    s_add_u32 s13, s13, s53
    v_and_b32 v13, 15, v0
    v_lshrrev_b32 v14, 4, v0
    v_bfe_u32 v15, v0, 1, 3
    v_xor_b32 v15, v15, v14
    v_lshlrev_b32 v15, 4, v15
    v_lshl_add_u32 v15, v13, 7, v15
    s_lshl_b32 s52, s25, 12
    v_add_u32 v1, s52, v15
    v_xor_b32 v2, 64, v1
    v_add_u32 v3, 0x10000, v1
    v_add_u32 v4, 0x10000, v2
    v_bfe_u32 v15, v0, 2, 2
    v_lshl_add_u32 v13, v14, 3, v15
    v_lshlrev_b32 v13, 6, v13
    v_bfe_u32 v15, v0, 4, 1
    v_lshl_add_u32 v13, v15, 5, v13
    v_and_b32 v15, 3, v0
    v_lshl_add_u32 v13, v15, 3, v13
    v_add_u32 v5, 98304, v13
    v_xor_b32 v6, 32, v5
    s_and_b32 s52, s25, 3
    s_lshl_b32 s52, s52, 11
    s_lshr_b32 s53, s25, 2
    s_lshl_b32 s53, s53, 14
    s_add_u32 s52, s52, s53
    v_add_u32 v96, s52, v121
    v_and_b32 v13, 15, v0
    v_lshlrev_b32 v13, 4, v13
    v_lshrrev_b32 v14, 5, v0
    v_lshl_add_u32 v13, v14, 8, v13
    v_bfe_u32 v15, v0, 4, 1
    v_lshl_add_u32 v13, v15, 13, v13
    s_add_u32 s52, s52, 1024
    v_add_u32 v97, s52, v13
    s_add_u32 s52, s62, 65536
    v_add_u32 v123, s52, v121
    s_add_u32 s0, s55, 8192
    v_lshlrev_b32 v7, 7, v0
    s_cmp_lg_u32 s25, 5
    s_cbranch_scc1 L_kvpre_done
    s_mov_b64 exec, 0xffff
    buffer_load_dword v125, v7, s[36:39], s60 offen sc1
    s_mov_b64 exec, -1
L_kvpre_done:
    s_cmp_lg_u32 s25, 6
    s_cbranch_scc1 L_c3_done
    s_and_b32 s52, s24, 1
    s_lshl_b32 s52, s52, 4
    s_add_u32 s52, s52, s23
    s_mul_i32 s52, s52, 36
    s_and_b32 s53, s24, 6
    s_add_u32 s53, s53, 2
    s_mul_i32 s53, s53, 192
    s_add_u32 s52, s52, s53
    v_add_u32 v13, s52, v0
    v_subrev_u32 v14, 1536, v13
    v_min_u32 v13, v13, v14
    v_lshlrev_b32 v13, 10, v13
    v_cmp_gt_u32 vcc, 36, v0
    s_mov_b32 s52, 384
    s_nop 0
    s_and_saveexec_b64 s[56:57], vcc
    buffer_load_dword v125, v13, s[32:35], s52 offen
    s_mov_b64 exec, -1
L_c3_done:
    s_mov_b32 s56, 0x3eb8aa3b
    s_mov_b32 s57, 0x3eb8aa3b
    s_barrier
    ds_read_b128 v[64:67], v1 offset:0
    ds_read_b64_tr_b16 v[80:81], v5 offset:4096
    ds_read_b64_tr_b16 v[82:83], v5 offset:4352
    ds_read_b64_tr_b16 v[84:85], v6 offset:4096
    ds_read_b64_tr_b16 v[86:87], v6 offset:4352
    ds_read_b64_tr_b16 v[88:89], v5 offset:8192
    ds_read_b64_tr_b16 v[90:91], v5 offset:8448
    ds_read_b64_tr_b16 v[92:93], v6 offset:8192
    ds_read_b64_tr_b16 v[94:95], v6 offset:8448
    ds_read_b64_tr_b16 v[72:73], v5 offset:0
    ds_read_b64_tr_b16 v[74:75], v5 offset:256
    ds_read_b64_tr_b16 v[76:77], v6 offset:0
    ds_read_b64_tr_b16 v[78:79], v6 offset:256
    ds_read_b128 v[68:71], v1 offset:2048
    s_waitcnt lgkmcnt(11)
    v_mfma_f32_16x16x32_bf16 v[32:35], v[80:83], v[64:67], 0
    s_waitcnt lgkmcnt(9)
    v_mfma_f32_16x16x32_bf16 v[40:43], v[84:87], v[64:67], 0
    s_waitcnt lgkmcnt(7)
    v_mfma_f32_16x16x32_bf16 v[48:51], v[64:67], v[88:91], 0
    s_waitcnt lgkmcnt(5)
    v_mfma_f32_16x16x32_bf16 v[56:59], v[64:67], v[92:95], 0
    s_waitcnt lgkmcnt(3)
    v_mfma_f32_16x16x32_bf16 v[16:19], v[72:75], v[64:67], 0
    s_waitcnt lgkmcnt(1)
    v_mfma_f32_16x16x32_bf16 v[24:27], v[76:79], v[64:67], 0
    ds_read_b128 v[64:67], v2 offset:0
    s_waitcnt lgkmcnt(1)
    v_mfma_f32_16x16x32_bf16 v[36:39], v[80:83], v[68:71], 0
    ds_read_b64_tr_b16 v[80:81], v5 offset:6144
    ds_read_b64_tr_b16 v[82:83], v5 offset:6400
    v_mfma_f32_16x16x32_bf16 v[44:47], v[84:87], v[68:71], 0
    ds_read_b64_tr_b16 v[84:85], v6 offset:6144
    ds_read_b64_tr_b16 v[86:87], v6 offset:6400
    v_mfma_f32_16x16x32_bf16 v[52:55], v[68:71], v[88:91], 0
    ds_read_b64_tr_b16 v[88:89], v5 offset:10240
    ds_read_b64_tr_b16 v[90:91], v5 offset:10496
    v_mfma_f32_16x16x32_bf16 v[60:63], v[68:71], v[92:95], 0
    ds_read_b64_tr_b16 v[92:93], v6 offset:10240
    ds_read_b64_tr_b16 v[94:95], v6 offset:10496
    v_mfma_f32_16x16x32_bf16 v[20:23], v[72:75], v[68:71], 0
    ds_read_b64_tr_b16 v[72:73], v5 offset:2048
    ds_read_b64_tr_b16 v[74:75], v5 offset:2304
    v_mfma_f32_16x16x32_bf16 v[28:31], v[76:79], v[68:71], 0
    ds_read_b64_tr_b16 v[76:77], v6 offset:2048
    ds_read_b64_tr_b16 v[78:79], v6 offset:2304
    ds_read_b128 v[68:71], v2 offset:2048
    s_waitcnt lgkmcnt(11)
    v_mfma_f32_16x16x32_bf16 v[32:35], v[80:83], v[64:67], v[32:35]
    s_waitcnt lgkmcnt(9)
    v_mfma_f32_16x16x32_bf16 v[40:43], v[84:87], v[64:67], v[40:43]
    s_waitcnt lgkmcnt(7)
    v_mfma_f32_16x16x32_bf16 v[48:51], v[64:67], v[88:91], v[48:51]
    s_waitcnt lgkmcnt(5)
    v_mfma_f32_16x16x32_bf16 v[56:59], v[64:67], v[92:95], v[56:59]
    s_waitcnt lgkmcnt(3)
    v_mfma_f32_16x16x32_bf16 v[16:19], v[72:75], v[64:67], v[16:19]
    s_waitcnt lgkmcnt(1)
    v_mfma_f32_16x16x32_bf16 v[24:27], v[76:79], v[64:67], v[24:27]
    s_waitcnt lgkmcnt(0)
    s_barrier
    ds_read_b128 v[64:67], v1 offset:32768
    v_mfma_f32_16x16x32_bf16 v[36:39], v[80:83], v[68:71], v[36:39]
    ds_read_b64_tr_b16 v[80:81], v5 offset:16384
    ds_read_b64_tr_b16 v[82:83], v5 offset:16640
    v_mfma_f32_16x16x32_bf16 v[44:47], v[84:87], v[68:71], v[44:47]
    ds_read_b64_tr_b16 v[84:85], v6 offset:16384
    ds_read_b64_tr_b16 v[86:87], v6 offset:16640
    v_mfma_f32_16x16x32_bf16 v[52:55], v[68:71], v[88:91], v[52:55]
    ds_read_b64_tr_b16 v[88:89], v5 offset:20480
    ds_read_b64_tr_b16 v[90:91], v5 offset:20736
    v_mfma_f32_16x16x32_bf16 v[60:63], v[68:71], v[92:95], v[60:63]
    ds_read_b64_tr_b16 v[92:93], v6 offset:20480
    ds_read_b64_tr_b16 v[94:95], v6 offset:20736
    v_mfma_f32_16x16x32_bf16 v[20:23], v[72:75], v[68:71], v[20:23]
    ds_read_b64_tr_b16 v[72:73], v5 offset:12288
    ds_read_b64_tr_b16 v[74:75], v5 offset:12544
    v_mfma_f32_16x16x32_bf16 v[28:31], v[76:79], v[68:71], v[28:31]
    ds_read_b64_tr_b16 v[76:77], v6 offset:12288
    ds_read_b64_tr_b16 v[78:79], v6 offset:12544
    ds_read_b128 v[68:71], v1 offset:34816
    s_waitcnt lgkmcnt(11)
    v_mfma_f32_16x16x32_bf16 v[32:35], v[80:83], v[64:67], v[32:35]
    s_waitcnt lgkmcnt(9)
    v_mfma_f32_16x16x32_bf16 v[40:43], v[84:87], v[64:67], v[40:43]
    s_waitcnt lgkmcnt(7)
    v_mfma_f32_16x16x32_bf16 v[48:51], v[64:67], v[88:91], v[48:51]
    s_waitcnt lgkmcnt(5)
    v_mfma_f32_16x16x32_bf16 v[56:59], v[64:67], v[92:95], v[56:59]
    s_waitcnt lgkmcnt(3)
    v_mfma_f32_16x16x32_bf16 v[16:19], v[72:75], v[64:67], v[16:19]
    s_waitcnt lgkmcnt(1)
    v_mfma_f32_16x16x32_bf16 v[24:27], v[76:79], v[64:67], v[24:27]
    ds_read_b128 v[64:67], v2 offset:32768
    s_waitcnt lgkmcnt(1)
    v_mfma_f32_16x16x32_bf16 v[36:39], v[80:83], v[68:71], v[36:39]
    ds_read_b64_tr_b16 v[80:81], v5 offset:18432
    ds_read_b64_tr_b16 v[82:83], v5 offset:18688
    v_mfma_f32_16x16x32_bf16 v[44:47], v[84:87], v[68:71], v[44:47]
    ds_read_b64_tr_b16 v[84:85], v6 offset:18432
    ds_read_b64_tr_b16 v[86:87], v6 offset:18688
    v_mfma_f32_16x16x32_bf16 v[52:55], v[68:71], v[88:91], v[52:55]
    ds_read_b64_tr_b16 v[88:89], v5 offset:22528
    ds_read_b64_tr_b16 v[90:91], v5 offset:22784
    v_mfma_f32_16x16x32_bf16 v[60:63], v[68:71], v[92:95], v[60:63]
    ds_read_b64_tr_b16 v[92:93], v6 offset:22528
    ds_read_b64_tr_b16 v[94:95], v6 offset:22784
    v_mfma_f32_16x16x32_bf16 v[20:23], v[72:75], v[68:71], v[20:23]
    ds_read_b64_tr_b16 v[72:73], v5 offset:14336
    ds_read_b64_tr_b16 v[74:75], v5 offset:14592
    v_mfma_f32_16x16x32_bf16 v[28:31], v[76:79], v[68:71], v[28:31]
    ds_read_b64_tr_b16 v[76:77], v6 offset:14336
    ds_read_b64_tr_b16 v[78:79], v6 offset:14592
    ds_read_b128 v[68:71], v2 offset:34816
    s_waitcnt lgkmcnt(11)
    v_mfma_f32_16x16x32_bf16 v[32:35], v[80:83], v[64:67], v[32:35]
    s_waitcnt lgkmcnt(9)
    v_mfma_f32_16x16x32_bf16 v[40:43], v[84:87], v[64:67], v[40:43]
    s_waitcnt lgkmcnt(7)
    v_mfma_f32_16x16x32_bf16 v[48:51], v[64:67], v[88:91], v[48:51]
    s_waitcnt lgkmcnt(5)
    v_mfma_f32_16x16x32_bf16 v[56:59], v[64:67], v[92:95], v[56:59]
    s_waitcnt lgkmcnt(3)
    v_mfma_f32_16x16x32_bf16 v[16:19], v[72:75], v[64:67], v[16:19]
    s_waitcnt lgkmcnt(1)
    v_mfma_f32_16x16x32_bf16 v[24:27], v[76:79], v[64:67], v[24:27]
    s_waitcnt lgkmcnt(0)
    s_barrier
    ds_read_b128 v[64:67], v3 offset:0
    v_mfma_f32_16x16x32_bf16 v[36:39], v[80:83], v[68:71], v[36:39]
    ds_read_b64_tr_b16 v[80:81], v5 offset:28672
    ds_read_b64_tr_b16 v[82:83], v5 offset:28928
    v_mfma_f32_16x16x32_bf16 v[44:47], v[84:87], v[68:71], v[44:47]
    ds_read_b64_tr_b16 v[84:85], v6 offset:28672
    ds_read_b64_tr_b16 v[86:87], v6 offset:28928
    v_mfma_f32_16x16x32_bf16 v[52:55], v[68:71], v[88:91], v[52:55]
    ds_read_b64_tr_b16 v[88:89], v5 offset:32768
    ds_read_b64_tr_b16 v[90:91], v5 offset:33024
    v_mfma_f32_16x16x32_bf16 v[60:63], v[68:71], v[92:95], v[60:63]
    ds_read_b64_tr_b16 v[92:93], v6 offset:32768
    ds_read_b64_tr_b16 v[94:95], v6 offset:33024
    v_mfma_f32_16x16x32_bf16 v[20:23], v[72:75], v[68:71], v[20:23]
    ds_read_b64_tr_b16 v[72:73], v5 offset:24576
    ds_read_b64_tr_b16 v[74:75], v5 offset:24832
    v_mfma_f32_16x16x32_bf16 v[28:31], v[76:79], v[68:71], v[28:31]
    ds_read_b64_tr_b16 v[76:77], v6 offset:24576
    ds_read_b64_tr_b16 v[78:79], v6 offset:24832
    ds_read_b128 v[68:71], v3 offset:2048
    s_waitcnt lgkmcnt(11)
    v_mfma_f32_16x16x32_bf16 v[32:35], v[80:83], v[64:67], v[32:35]
    s_waitcnt lgkmcnt(9)
    v_mfma_f32_16x16x32_bf16 v[40:43], v[84:87], v[64:67], v[40:43]
    s_waitcnt lgkmcnt(7)
    v_mfma_f32_16x16x32_bf16 v[48:51], v[64:67], v[88:91], v[48:51]
    s_waitcnt lgkmcnt(5)
    v_mfma_f32_16x16x32_bf16 v[56:59], v[64:67], v[92:95], v[56:59]
    s_waitcnt lgkmcnt(3)
    v_mfma_f32_16x16x32_bf16 v[16:19], v[72:75], v[64:67], v[16:19]
    s_waitcnt lgkmcnt(1)
    v_mfma_f32_16x16x32_bf16 v[24:27], v[76:79], v[64:67], v[24:27]
    ds_read_b128 v[64:67], v4 offset:0
    s_waitcnt lgkmcnt(1)
    v_mfma_f32_16x16x32_bf16 v[36:39], v[80:83], v[68:71], v[36:39]
    ds_read_b64_tr_b16 v[80:81], v5 offset:30720
    ds_read_b64_tr_b16 v[82:83], v5 offset:30976
    v_mfma_f32_16x16x32_bf16 v[44:47], v[84:87], v[68:71], v[44:47]
    ds_read_b64_tr_b16 v[84:85], v6 offset:30720
    ds_read_b64_tr_b16 v[86:87], v6 offset:30976
    v_mfma_f32_16x16x32_bf16 v[52:55], v[68:71], v[88:91], v[52:55]
    ds_read_b64_tr_b16 v[88:89], v5 offset:34816
    ds_read_b64_tr_b16 v[90:91], v5 offset:35072
    v_mfma_f32_16x16x32_bf16 v[60:63], v[68:71], v[92:95], v[60:63]
    ds_read_b64_tr_b16 v[92:93], v6 offset:34816
    ds_read_b64_tr_b16 v[94:95], v6 offset:35072
    v_mfma_f32_16x16x32_bf16 v[20:23], v[72:75], v[68:71], v[20:23]
    ds_read_b64_tr_b16 v[72:73], v5 offset:26624
    ds_read_b64_tr_b16 v[74:75], v5 offset:26880
    v_mfma_f32_16x16x32_bf16 v[28:31], v[76:79], v[68:71], v[28:31]
    ds_read_b64_tr_b16 v[76:77], v6 offset:26624
    ds_read_b64_tr_b16 v[78:79], v6 offset:26880
    ds_read_b128 v[68:71], v4 offset:2048
    s_waitcnt lgkmcnt(11)
    v_mfma_f32_16x16x32_bf16 v[32:35], v[80:83], v[64:67], v[32:35]
    s_waitcnt lgkmcnt(9)
    v_mfma_f32_16x16x32_bf16 v[40:43], v[84:87], v[64:67], v[40:43]
    s_waitcnt lgkmcnt(7)
    v_mfma_f32_16x16x32_bf16 v[48:51], v[64:67], v[88:91], v[48:51]
    s_waitcnt lgkmcnt(5)
    v_mfma_f32_16x16x32_bf16 v[56:59], v[64:67], v[92:95], v[56:59]
    s_waitcnt lgkmcnt(3)
    v_mfma_f32_16x16x32_bf16 v[16:19], v[72:75], v[64:67], v[16:19]
    s_waitcnt lgkmcnt(1)
    v_mfma_f32_16x16x32_bf16 v[24:27], v[76:79], v[64:67], v[24:27]
    s_waitcnt lgkmcnt(0)
    s_barrier
    ds_read_b128 v[64:67], v1 offset:0
    v_mfma_f32_16x16x32_bf16 v[36:39], v[80:83], v[68:71], v[36:39]
    ds_read_b64_tr_b16 v[80:81], v5 offset:4096
    ds_read_b64_tr_b16 v[82:83], v5 offset:4352
    v_mfma_f32_16x16x32_bf16 v[44:47], v[84:87], v[68:71], v[44:47]
    ds_read_b64_tr_b16 v[84:85], v6 offset:4096
    ds_read_b64_tr_b16 v[86:87], v6 offset:4352
    v_mfma_f32_16x16x32_bf16 v[52:55], v[68:71], v[88:91], v[52:55]
    ds_read_b64_tr_b16 v[88:89], v5 offset:8192
    ds_read_b64_tr_b16 v[90:91], v5 offset:8448
    v_mfma_f32_16x16x32_bf16 v[60:63], v[68:71], v[92:95], v[60:63]
    ds_read_b64_tr_b16 v[92:93], v6 offset:8192
    ds_read_b64_tr_b16 v[94:95], v6 offset:8448
    v_mfma_f32_16x16x32_bf16 v[20:23], v[72:75], v[68:71], v[20:23]
    ds_read_b64_tr_b16 v[72:73], v5 offset:0
    ds_read_b64_tr_b16 v[74:75], v5 offset:256
    v_mfma_f32_16x16x32_bf16 v[28:31], v[76:79], v[68:71], v[28:31]
    ds_read_b64_tr_b16 v[76:77], v6 offset:0
    ds_read_b64_tr_b16 v[78:79], v6 offset:256
    ds_read_b128 v[68:71], v1 offset:2048
    s_waitcnt lgkmcnt(11)
    v_mfma_f32_16x16x32_bf16 v[32:35], v[80:83], v[64:67], v[32:35]
    s_waitcnt lgkmcnt(9)
    v_mfma_f32_16x16x32_bf16 v[40:43], v[84:87], v[64:67], v[40:43]
    s_waitcnt lgkmcnt(7)
    v_mfma_f32_16x16x32_bf16 v[48:51], v[64:67], v[88:91], v[48:51]
    s_waitcnt lgkmcnt(5)
    v_mfma_f32_16x16x32_bf16 v[56:59], v[64:67], v[92:95], v[56:59]
    s_waitcnt lgkmcnt(3)
    v_mfma_f32_16x16x32_bf16 v[16:19], v[72:75], v[64:67], v[16:19]
    s_waitcnt lgkmcnt(1)
    v_mfma_f32_16x16x32_bf16 v[24:27], v[76:79], v[64:67], v[24:27]
    ds_read_b128 v[64:67], v2 offset:0
    s_waitcnt lgkmcnt(1)
    v_mfma_f32_16x16x32_bf16 v[36:39], v[80:83], v[68:71], v[36:39]
    ds_read_b64_tr_b16 v[80:81], v5 offset:6144
    ds_read_b64_tr_b16 v[82:83], v5 offset:6400
    v_mfma_f32_16x16x32_bf16 v[44:47], v[84:87], v[68:71], v[44:47]
    ds_read_b64_tr_b16 v[84:85], v6 offset:6144
    ds_read_b64_tr_b16 v[86:87], v6 offset:6400
    v_mfma_f32_16x16x32_bf16 v[52:55], v[68:71], v[88:91], v[52:55]
    ds_read_b64_tr_b16 v[88:89], v5 offset:10240
    ds_read_b64_tr_b16 v[90:91], v5 offset:10496
    v_mfma_f32_16x16x32_bf16 v[60:63], v[68:71], v[92:95], v[60:63]
    ds_read_b64_tr_b16 v[92:93], v6 offset:10240
    ds_read_b64_tr_b16 v[94:95], v6 offset:10496
    v_mfma_f32_16x16x32_bf16 v[20:23], v[72:75], v[68:71], v[20:23]
    ds_read_b64_tr_b16 v[72:73], v5 offset:2048
    ds_read_b64_tr_b16 v[74:75], v5 offset:2304
    v_mfma_f32_16x16x32_bf16 v[28:31], v[76:79], v[68:71], v[28:31]
    ds_read_b64_tr_b16 v[76:77], v6 offset:2048
    ds_read_b64_tr_b16 v[78:79], v6 offset:2304
    ds_read_b128 v[68:71], v2 offset:2048
    s_waitcnt lgkmcnt(11)
    v_mfma_f32_16x16x32_bf16 v[32:35], v[80:83], v[64:67], v[32:35]
    s_waitcnt lgkmcnt(9)
    v_mfma_f32_16x16x32_bf16 v[40:43], v[84:87], v[64:67], v[40:43]
    s_waitcnt lgkmcnt(7)
    v_mfma_f32_16x16x32_bf16 v[48:51], v[64:67], v[88:91], v[48:51]
    s_waitcnt lgkmcnt(5)
    v_mfma_f32_16x16x32_bf16 v[56:59], v[64:67], v[92:95], v[56:59]
    s_waitcnt lgkmcnt(3)
    v_mfma_f32_16x16x32_bf16 v[16:19], v[72:75], v[64:67], v[16:19]
    s_waitcnt lgkmcnt(1)
    v_mfma_f32_16x16x32_bf16 v[24:27], v[76:79], v[64:67], v[24:27]
    s_waitcnt lgkmcnt(0)
    s_barrier
    ds_read_b128 v[64:67], v1 offset:32768
    v_mfma_f32_16x16x32_bf16 v[36:39], v[80:83], v[68:71], v[36:39]
    ds_read_b64_tr_b16 v[80:81], v5 offset:16384
    ds_read_b64_tr_b16 v[82:83], v5 offset:16640
    v_mfma_f32_16x16x32_bf16 v[44:47], v[84:87], v[68:71], v[44:47]
    ds_read_b64_tr_b16 v[84:85], v6 offset:16384
    ds_read_b64_tr_b16 v[86:87], v6 offset:16640
    v_mfma_f32_16x16x32_bf16 v[52:55], v[68:71], v[88:91], v[52:55]
    ds_read_b64_tr_b16 v[88:89], v5 offset:20480
    ds_read_b64_tr_b16 v[90:91], v5 offset:20736
    v_mfma_f32_16x16x32_bf16 v[60:63], v[68:71], v[92:95], v[60:63]
    ds_read_b64_tr_b16 v[92:93], v6 offset:20480
    ds_read_b64_tr_b16 v[94:95], v6 offset:20736
    v_mfma_f32_16x16x32_bf16 v[20:23], v[72:75], v[68:71], v[20:23]
    ds_read_b64_tr_b16 v[72:73], v5 offset:12288
    ds_read_b64_tr_b16 v[74:75], v5 offset:12544
    v_mfma_f32_16x16x32_bf16 v[28:31], v[76:79], v[68:71], v[28:31]
    ds_read_b64_tr_b16 v[76:77], v6 offset:12288
    ds_read_b64_tr_b16 v[78:79], v6 offset:12544
    ds_read_b128 v[68:71], v1 offset:34816
    s_waitcnt lgkmcnt(11)
    v_mfma_f32_16x16x32_bf16 v[32:35], v[80:83], v[64:67], v[32:35]
    s_waitcnt lgkmcnt(9)
    v_mfma_f32_16x16x32_bf16 v[40:43], v[84:87], v[64:67], v[40:43]
    s_waitcnt lgkmcnt(7)
    v_mfma_f32_16x16x32_bf16 v[48:51], v[64:67], v[88:91], v[48:51]
    s_waitcnt lgkmcnt(5)
    v_mfma_f32_16x16x32_bf16 v[56:59], v[64:67], v[92:95], v[56:59]
    s_waitcnt lgkmcnt(3)
    v_mfma_f32_16x16x32_bf16 v[16:19], v[72:75], v[64:67], v[16:19]
    s_waitcnt lgkmcnt(1)
    v_mfma_f32_16x16x32_bf16 v[24:27], v[76:79], v[64:67], v[24:27]
    ds_read_b128 v[64:67], v2 offset:32768
    s_waitcnt lgkmcnt(1)
    v_mfma_f32_16x16x32_bf16 v[36:39], v[80:83], v[68:71], v[36:39]
    ds_read_b64_tr_b16 v[80:81], v5 offset:18432
    ds_read_b64_tr_b16 v[82:83], v5 offset:18688
    v_mfma_f32_16x16x32_bf16 v[44:47], v[84:87], v[68:71], v[44:47]
    ds_read_b64_tr_b16 v[84:85], v6 offset:18432
    ds_read_b64_tr_b16 v[86:87], v6 offset:18688
    v_mfma_f32_16x16x32_bf16 v[52:55], v[68:71], v[88:91], v[52:55]
    ds_read_b64_tr_b16 v[88:89], v5 offset:22528
    ds_read_b64_tr_b16 v[90:91], v5 offset:22784
    v_mfma_f32_16x16x32_bf16 v[60:63], v[68:71], v[92:95], v[60:63]
    ds_read_b64_tr_b16 v[92:93], v6 offset:22528
    ds_read_b64_tr_b16 v[94:95], v6 offset:22784
    v_mfma_f32_16x16x32_bf16 v[20:23], v[72:75], v[68:71], v[20:23]
    ds_read_b64_tr_b16 v[72:73], v5 offset:14336
    ds_read_b64_tr_b16 v[74:75], v5 offset:14592
    v_mfma_f32_16x16x32_bf16 v[28:31], v[76:79], v[68:71], v[28:31]
    ds_read_b64_tr_b16 v[76:77], v6 offset:14336
    ds_read_b64_tr_b16 v[78:79], v6 offset:14592
    ds_read_b128 v[68:71], v2 offset:34816
    s_waitcnt lgkmcnt(11)
    v_mfma_f32_16x16x32_bf16 v[32:35], v[80:83], v[64:67], v[32:35]
    s_waitcnt lgkmcnt(9)
    v_mfma_f32_16x16x32_bf16 v[40:43], v[84:87], v[64:67], v[40:43]
    s_waitcnt lgkmcnt(7)
    v_mfma_f32_16x16x32_bf16 v[48:51], v[64:67], v[88:91], v[48:51]
    s_waitcnt lgkmcnt(5)
    v_mfma_f32_16x16x32_bf16 v[56:59], v[64:67], v[92:95], v[56:59]
    s_waitcnt lgkmcnt(3)
    v_mfma_f32_16x16x32_bf16 v[16:19], v[72:75], v[64:67], v[16:19]
    s_waitcnt lgkmcnt(1)
    v_mfma_f32_16x16x32_bf16 v[24:27], v[76:79], v[64:67], v[24:27]
    s_waitcnt lgkmcnt(0)
    s_barrier
    ds_read_b128 v[64:67], v3 offset:0
    v_mfma_f32_16x16x32_bf16 v[36:39], v[80:83], v[68:71], v[36:39]
    ds_read_b64_tr_b16 v[80:81], v5 offset:28672
    ds_read_b64_tr_b16 v[82:83], v5 offset:28928
    v_mfma_f32_16x16x32_bf16 v[44:47], v[84:87], v[68:71], v[44:47]
    ds_read_b64_tr_b16 v[84:85], v6 offset:28672
    ds_read_b64_tr_b16 v[86:87], v6 offset:28928
    v_mfma_f32_16x16x32_bf16 v[52:55], v[68:71], v[88:91], v[52:55]
    ds_read_b64_tr_b16 v[88:89], v5 offset:32768
    ds_read_b64_tr_b16 v[90:91], v5 offset:33024
    v_mfma_f32_16x16x32_bf16 v[60:63], v[68:71], v[92:95], v[60:63]
    ds_read_b64_tr_b16 v[92:93], v6 offset:32768
    ds_read_b64_tr_b16 v[94:95], v6 offset:33024
    v_mfma_f32_16x16x32_bf16 v[20:23], v[72:75], v[68:71], v[20:23]
    ds_read_b64_tr_b16 v[72:73], v5 offset:24576
    ds_read_b64_tr_b16 v[74:75], v5 offset:24832
    v_mfma_f32_16x16x32_bf16 v[28:31], v[76:79], v[68:71], v[28:31]
    ds_read_b64_tr_b16 v[76:77], v6 offset:24576
    ds_read_b64_tr_b16 v[78:79], v6 offset:24832
    ds_read_b128 v[68:71], v3 offset:2048
    s_waitcnt lgkmcnt(11)
    v_mfma_f32_16x16x32_bf16 v[32:35], v[80:83], v[64:67], v[32:35]
    s_waitcnt lgkmcnt(9)
    v_mfma_f32_16x16x32_bf16 v[40:43], v[84:87], v[64:67], v[40:43]
    s_waitcnt lgkmcnt(7)
    v_mfma_f32_16x16x32_bf16 v[48:51], v[64:67], v[88:91], v[48:51]
    s_waitcnt lgkmcnt(5)
    v_mfma_f32_16x16x32_bf16 v[56:59], v[64:67], v[92:95], v[56:59]
    s_waitcnt lgkmcnt(3)
    v_mfma_f32_16x16x32_bf16 v[16:19], v[72:75], v[64:67], v[16:19]
    s_waitcnt lgkmcnt(1)
    v_mfma_f32_16x16x32_bf16 v[24:27], v[76:79], v[64:67], v[24:27]
    ds_read_b128 v[64:67], v4 offset:0
    s_waitcnt lgkmcnt(1)
    v_mfma_f32_16x16x32_bf16 v[36:39], v[80:83], v[68:71], v[36:39]
    ds_read_b64_tr_b16 v[80:81], v5 offset:30720
    ds_read_b64_tr_b16 v[82:83], v5 offset:30976
    v_mfma_f32_16x16x32_bf16 v[44:47], v[84:87], v[68:71], v[44:47]
    ds_read_b64_tr_b16 v[84:85], v6 offset:30720
    ds_read_b64_tr_b16 v[86:87], v6 offset:30976
    v_mfma_f32_16x16x32_bf16 v[52:55], v[68:71], v[88:91], v[52:55]
    ds_read_b64_tr_b16 v[88:89], v5 offset:34816
    ds_read_b64_tr_b16 v[90:91], v5 offset:35072
    v_mfma_f32_16x16x32_bf16 v[60:63], v[68:71], v[92:95], v[60:63]
    ds_read_b64_tr_b16 v[92:93], v6 offset:34816
    ds_read_b64_tr_b16 v[94:95], v6 offset:35072
    v_mfma_f32_16x16x32_bf16 v[20:23], v[72:75], v[68:71], v[20:23]
    ds_read_b64_tr_b16 v[72:73], v5 offset:26624
    ds_read_b64_tr_b16 v[74:75], v5 offset:26880
    v_mfma_f32_16x16x32_bf16 v[28:31], v[76:79], v[68:71], v[28:31]
    ds_read_b64_tr_b16 v[76:77], v6 offset:26624
    ds_read_b64_tr_b16 v[78:79], v6 offset:26880
    ds_read_b128 v[68:71], v4 offset:2048
    s_waitcnt lgkmcnt(11)
    v_mfma_f32_16x16x32_bf16 v[32:35], v[80:83], v[64:67], v[32:35]
    s_waitcnt lgkmcnt(9)
    v_mfma_f32_16x16x32_bf16 v[40:43], v[84:87], v[64:67], v[40:43]
    s_waitcnt lgkmcnt(7)
    v_mfma_f32_16x16x32_bf16 v[48:51], v[64:67], v[88:91], v[48:51]
    s_waitcnt lgkmcnt(5)
    v_mfma_f32_16x16x32_bf16 v[56:59], v[64:67], v[92:95], v[56:59]
    s_waitcnt lgkmcnt(3)
    v_mfma_f32_16x16x32_bf16 v[16:19], v[72:75], v[64:67], v[16:19]
    s_waitcnt lgkmcnt(1)
    v_mfma_f32_16x16x32_bf16 v[24:27], v[76:79], v[64:67], v[24:27]
    s_waitcnt lgkmcnt(0)
    s_barrier
    s_waitcnt vmcnt(0)
    ds_read_b128 v[64:67], v1 offset:0
    v_mfma_f32_16x16x32_bf16 v[36:39], v[80:83], v[68:71], v[36:39]
    ds_read_b64_tr_b16 v[80:81], v5 offset:4096
    ds_read_b64_tr_b16 v[82:83], v5 offset:4352
    v_mfma_f32_16x16x32_bf16 v[44:47], v[84:87], v[68:71], v[44:47]
    ds_read_b64_tr_b16 v[84:85], v6 offset:4096
    ds_read_b64_tr_b16 v[86:87], v6 offset:4352
    v_mfma_f32_16x16x32_bf16 v[52:55], v[68:71], v[88:91], v[52:55]
    ds_read_b64_tr_b16 v[88:89], v5 offset:8192
    ds_read_b64_tr_b16 v[90:91], v5 offset:8448
    v_mfma_f32_16x16x32_bf16 v[60:63], v[68:71], v[92:95], v[60:63]
    ds_read_b64_tr_b16 v[92:93], v6 offset:8192
    ds_read_b64_tr_b16 v[94:95], v6 offset:8448
    v_mfma_f32_16x16x32_bf16 v[20:23], v[72:75], v[68:71], v[20:23]
    ds_read_b64_tr_b16 v[72:73], v5 offset:0
    ds_read_b64_tr_b16 v[74:75], v5 offset:256
    v_mfma_f32_16x16x32_bf16 v[28:31], v[76:79], v[68:71], v[28:31]
    ds_read_b64_tr_b16 v[76:77], v6 offset:0
    ds_read_b64_tr_b16 v[78:79], v6 offset:256
    ds_read_b128 v[68:71], v1 offset:2048
    s_waitcnt lgkmcnt(11)
    v_mfma_f32_16x16x32_bf16 v[32:35], v[80:83], v[64:67], v[32:35]
    s_waitcnt lgkmcnt(9)
    v_mfma_f32_16x16x32_bf16 v[40:43], v[84:87], v[64:67], v[40:43]
    s_waitcnt lgkmcnt(7)
    v_mfma_f32_16x16x32_bf16 v[48:51], v[64:67], v[88:91], v[48:51]
    s_waitcnt lgkmcnt(5)
    v_mfma_f32_16x16x32_bf16 v[56:59], v[64:67], v[92:95], v[56:59]
    s_waitcnt lgkmcnt(3)
    v_mfma_f32_16x16x32_bf16 v[16:19], v[72:75], v[64:67], v[16:19]
    s_waitcnt lgkmcnt(1)
    v_mfma_f32_16x16x32_bf16 v[24:27], v[76:79], v[64:67], v[24:27]
    ds_read_b128 v[64:67], v2 offset:0
    s_waitcnt lgkmcnt(1)
    v_mfma_f32_16x16x32_bf16 v[36:39], v[80:83], v[68:71], v[36:39]
    ds_read_b64_tr_b16 v[80:81], v5 offset:6144
    ds_read_b64_tr_b16 v[82:83], v5 offset:6400
    v_mfma_f32_16x16x32_bf16 v[44:47], v[84:87], v[68:71], v[44:47]
    ds_read_b64_tr_b16 v[84:85], v6 offset:6144
    ds_read_b64_tr_b16 v[86:87], v6 offset:6400
    v_mfma_f32_16x16x32_bf16 v[52:55], v[68:71], v[88:91], v[52:55]
    ds_read_b64_tr_b16 v[88:89], v5 offset:10240
    ds_read_b64_tr_b16 v[90:91], v5 offset:10496
    v_mfma_f32_16x16x32_bf16 v[60:63], v[68:71], v[92:95], v[60:63]
    ds_read_b64_tr_b16 v[92:93], v6 offset:10240
    ds_read_b64_tr_b16 v[94:95], v6 offset:10496
    v_mfma_f32_16x16x32_bf16 v[20:23], v[72:75], v[68:71], v[20:23]
    ds_read_b64_tr_b16 v[72:73], v5 offset:2048
    ds_read_b64_tr_b16 v[74:75], v5 offset:2304
    v_mfma_f32_16x16x32_bf16 v[28:31], v[76:79], v[68:71], v[28:31]
    ds_read_b64_tr_b16 v[76:77], v6 offset:2048
    ds_read_b64_tr_b16 v[78:79], v6 offset:2304
    ds_read_b128 v[68:71], v2 offset:2048
    s_waitcnt lgkmcnt(11)
    v_mfma_f32_16x16x32_bf16 v[32:35], v[80:83], v[64:67], v[32:35]
    s_waitcnt lgkmcnt(9)
    v_mfma_f32_16x16x32_bf16 v[40:43], v[84:87], v[64:67], v[40:43]
    s_waitcnt lgkmcnt(7)
    v_mfma_f32_16x16x32_bf16 v[48:51], v[64:67], v[88:91], v[48:51]
    s_waitcnt lgkmcnt(5)
    v_mfma_f32_16x16x32_bf16 v[56:59], v[64:67], v[92:95], v[56:59]
    s_waitcnt lgkmcnt(3)
    v_mfma_f32_16x16x32_bf16 v[16:19], v[72:75], v[64:67], v[16:19]
    s_waitcnt lgkmcnt(1)
    v_mfma_f32_16x16x32_bf16 v[24:27], v[76:79], v[64:67], v[24:27]
    s_waitcnt lgkmcnt(0)
    s_barrier
    ds_read_b128 v[64:67], v1 offset:32768
    v_mfma_f32_16x16x32_bf16 v[36:39], v[80:83], v[68:71], v[36:39]
    ds_read_b64_tr_b16 v[80:81], v5 offset:16384
    ds_read_b64_tr_b16 v[82:83], v5 offset:16640
    v_mfma_f32_16x16x32_bf16 v[44:47], v[84:87], v[68:71], v[44:47]
    ds_read_b64_tr_b16 v[84:85], v6 offset:16384
    ds_read_b64_tr_b16 v[86:87], v6 offset:16640
    v_mfma_f32_16x16x32_bf16 v[52:55], v[68:71], v[88:91], v[52:55]
    ds_read_b64_tr_b16 v[88:89], v5 offset:20480
    ds_read_b64_tr_b16 v[90:91], v5 offset:20736
    v_mfma_f32_16x16x32_bf16 v[60:63], v[68:71], v[92:95], v[60:63]
    ds_read_b64_tr_b16 v[92:93], v6 offset:20480
    ds_read_b64_tr_b16 v[94:95], v6 offset:20736
    v_mfma_f32_16x16x32_bf16 v[20:23], v[72:75], v[68:71], v[20:23]
    ds_read_b64_tr_b16 v[72:73], v5 offset:12288
    ds_read_b64_tr_b16 v[74:75], v5 offset:12544
    v_mfma_f32_16x16x32_bf16 v[28:31], v[76:79], v[68:71], v[28:31]
    ds_read_b64_tr_b16 v[76:77], v6 offset:12288
    ds_read_b64_tr_b16 v[78:79], v6 offset:12544
    ds_read_b128 v[68:71], v1 offset:34816
    s_waitcnt lgkmcnt(11)
    v_mfma_f32_16x16x32_bf16 v[32:35], v[80:83], v[64:67], v[32:35]
    s_waitcnt lgkmcnt(9)
    v_mfma_f32_16x16x32_bf16 v[40:43], v[84:87], v[64:67], v[40:43]
    s_waitcnt lgkmcnt(7)
    v_mfma_f32_16x16x32_bf16 v[48:51], v[64:67], v[88:91], v[48:51]
    s_waitcnt lgkmcnt(5)
    v_mfma_f32_16x16x32_bf16 v[56:59], v[64:67], v[92:95], v[56:59]
    s_waitcnt lgkmcnt(3)
    v_mfma_f32_16x16x32_bf16 v[16:19], v[72:75], v[64:67], v[16:19]
    s_waitcnt lgkmcnt(1)
    v_mfma_f32_16x16x32_bf16 v[24:27], v[76:79], v[64:67], v[24:27]
    ds_read_b128 v[64:67], v2 offset:32768
    s_waitcnt lgkmcnt(1)
    v_mfma_f32_16x16x32_bf16 v[36:39], v[80:83], v[68:71], v[36:39]
    ds_read_b64_tr_b16 v[80:81], v5 offset:18432
    ds_read_b64_tr_b16 v[82:83], v5 offset:18688
    v_mfma_f32_16x16x32_bf16 v[44:47], v[84:87], v[68:71], v[44:47]
    ds_read_b64_tr_b16 v[84:85], v6 offset:18432
    ds_read_b64_tr_b16 v[86:87], v6 offset:18688
    v_mfma_f32_16x16x32_bf16 v[52:55], v[68:71], v[88:91], v[52:55]
    ds_read_b64_tr_b16 v[88:89], v5 offset:22528
    ds_read_b64_tr_b16 v[90:91], v5 offset:22784
    v_mfma_f32_16x16x32_bf16 v[60:63], v[68:71], v[92:95], v[60:63]
    ds_read_b64_tr_b16 v[92:93], v6 offset:22528
    ds_read_b64_tr_b16 v[94:95], v6 offset:22784
    v_mfma_f32_16x16x32_bf16 v[20:23], v[72:75], v[68:71], v[20:23]
    ds_read_b64_tr_b16 v[72:73], v5 offset:14336
    ds_read_b64_tr_b16 v[74:75], v5 offset:14592
    v_mfma_f32_16x16x32_bf16 v[28:31], v[76:79], v[68:71], v[28:31]
    ds_read_b64_tr_b16 v[76:77], v6 offset:14336
    ds_read_b64_tr_b16 v[78:79], v6 offset:14592
    ds_read_b128 v[68:71], v2 offset:34816
    s_waitcnt lgkmcnt(11)
    v_mfma_f32_16x16x32_bf16 v[32:35], v[80:83], v[64:67], v[32:35]
    s_waitcnt lgkmcnt(9)
    v_mfma_f32_16x16x32_bf16 v[40:43], v[84:87], v[64:67], v[40:43]
    s_waitcnt lgkmcnt(7)
    v_mfma_f32_16x16x32_bf16 v[48:51], v[64:67], v[88:91], v[48:51]
    s_waitcnt lgkmcnt(5)
    v_mfma_f32_16x16x32_bf16 v[56:59], v[64:67], v[92:95], v[56:59]
    s_waitcnt lgkmcnt(3)
    v_mfma_f32_16x16x32_bf16 v[16:19], v[72:75], v[64:67], v[16:19]
    s_waitcnt lgkmcnt(1)
    v_mfma_f32_16x16x32_bf16 v[24:27], v[76:79], v[64:67], v[24:27]
    s_waitcnt lgkmcnt(0)
    v_mfma_f32_16x16x32_bf16 v[36:39], v[80:83], v[68:71], v[36:39]
    v_mov_b32 v0, 0
    v_mov_b32 v1, 0
    v_mov_b32 v2, 0
    v_mov_b32 v3, 0
    v_mfma_f32_16x16x32_bf16 v[44:47], v[84:87], v[68:71], v[44:47]
    v_mov_b32 v4, 0
    v_mov_b32 v5, 0
    v_mov_b32 v6, 0
    v_mov_b32 v7, 0
    v_mfma_f32_16x16x32_bf16 v[52:55], v[68:71], v[88:91], v[52:55]
    v_mov_b32 v8, 0
    v_mov_b32 v9, 0
    v_mov_b32 v10, 0
    v_mov_b32 v11, 0
    v_mfma_f32_16x16x32_bf16 v[60:63], v[68:71], v[92:95], v[60:63]
    v_mov_b32 v12, 0
    v_mov_b32 v13, 0
    v_mov_b32 v14, 0
    v_mov_b32 v15, 0
    v_mfma_f32_16x16x32_bf16 v[20:23], v[72:75], v[68:71], v[20:23]
    v_mfma_f32_16x16x32_bf16 v[28:31], v[76:79], v[68:71], v[28:31]
    s_nop 2
    v_cvt_pk_bf16_f32 v64, v32, v33
    v_cvt_pk_bf16_f32 v65, v34, v35
    v_cvt_pk_bf16_f32 v66, v36, v37
    v_cvt_pk_bf16_f32 v67, v38, v39
    v_cvt_pk_bf16_f32 v68, v40, v41
    v_cvt_pk_bf16_f32 v69, v42, v43
    v_cvt_pk_bf16_f32 v70, v44, v45
    v_cvt_pk_bf16_f32 v71, v46, v47
    v_permlane16_swap_b32 v64, v66
    v_permlane16_swap_b32 v65, v67
    ds_write_b128 v96, v[64:67]
    v_cvt_pk_bf16_f32 v72, v48, v49
    v_cvt_pk_bf16_f32 v73, v50, v51
    v_cvt_pk_bf16_f32 v74, v56, v57
    v_cvt_pk_bf16_f32 v75, v58, v59
    v_permlane16_swap_b32 v68, v70
    v_permlane16_swap_b32 v69, v71
    ds_write_b128 v96, v[68:71] offset:8192
    v_cvt_pk_bf16_f32 v76, v52, v53
    v_cvt_pk_bf16_f32 v77, v54, v55
    v_cvt_pk_bf16_f32 v78, v60, v61
    v_cvt_pk_bf16_f32 v79, v62, v63
    v_permlane16_swap_b32 v72, v74
    v_permlane16_swap_b32 v73, v75
    ds_write_b128 v97, v[72:75]
    v_pk_mul_f32 v[24:25], v[24:25], s[56:57]
    v_pk_mul_f32 v[26:27], v[26:27], s[56:57]
    v_pk_mul_f32 v[28:29], v[28:29], s[56:57]
    v_pk_mul_f32 v[30:31], v[30:31], s[56:57]
    v_permlane16_swap_b32 v76, v78
    v_permlane16_swap_b32 v77, v79
    ds_write_b128 v97, v[76:79] offset:512
    v_cvt_pk_bf16_f32 v80, v24, v25
    v_cvt_pk_bf16_f32 v81, v26, v27
    v_cvt_pk_bf16_f32 v82, v28, v29
    v_cvt_pk_bf16_f32 v83, v30, v31
    v_pk_mul_f32 v[16:17], v[16:17], s[56:57]
    v_pk_mul_f32 v[18:19], v[18:19], s[56:57]
    v_pk_mul_f32 v[20:21], v[20:21], s[56:57]
    v_pk_mul_f32 v[22:23], v[22:23], s[56:57]
    v_permlane16_swap_b32 v80, v82
    v_permlane16_swap_b32 v81, v83
    ds_write_b128 v123, v[80:83]
    v_cvt_pk_bf16_f32 v16, v16, v17
    v_cvt_pk_bf16_f32 v17, v18, v19
    v_cvt_pk_bf16_f32 v18, v20, v21
    v_cvt_pk_bf16_f32 v19, v22, v23
    s_nop 1
    v_permlane16_swap_b32 v16, v18
    v_permlane16_swap_b32 v17, v19
    s_cmp_ge_u32 s25, 4
    s_cbranch_scc1 L_nost
    buffer_store_dwordx4 v[64:67], v96, s[36:39], s55 offen sc1
    buffer_store_dwordx4 v[68:71], v96, s[36:39], s0 offen sc1
    buffer_store_dwordx4 v[72:75], v97, s[36:39], s55 offen sc1
    buffer_store_dwordx4 v[76:79], v97, s[36:39], s55 offen offset:512 sc1
L_nost:
    s_waitcnt lgkmcnt(0)
    s_barrier
    s_branch L_haveq
L_p2_start:
    v_mov_b32 v96, 0
    v_mov_b32 v97, 0
    v_mov_b32 v0, 0
    v_mov_b32 v1, 0
    v_mov_b32 v2, 0
    v_mov_b32 v3, 0
    v_mov_b32 v4, 0
    v_mov_b32 v5, 0
    v_mov_b32 v6, 0
    v_mov_b32 v7, 0
    v_mov_b32 v8, 0
    v_mov_b32 v9, 0
    v_mov_b32 v10, 0
    v_mov_b32 v11, 0
    v_mov_b32 v12, 0
    v_mov_b32 v13, 0
    v_mov_b32 v14, 0
    v_mov_b32 v15, 0
    s_add_u32 s53, s62, 57344
    v_add_u32 v123, s53, v121
    s_waitcnt lgkmcnt(0)
    s_barrier
    ds_read_b128 v[16:19], v123
L_haveq:
    s_setprio 3
    s_cmp_lt_u32 s25, 4
    s_cselect_b32 s3, 1, 0
    ds_read_b128 v[52:55], v117 offset:0
    ds_read_b128 v[56:59], v117 offset:2048
    s_mov_b64 exec, s[50:51]
    ds_read_b128 v[100:103], v119 offset:0
    ds_read_b128 v[104:107], v119 offset:512
    s_mov_b64 exec, -1
    ds_read_b64 v[124:125], v122
    s_waitcnt lgkmcnt(4)
    v_mfma_f32_32x32x16_bf16 v[20:35], v[52:55], v[16:19], 0
    v_lshrrev_b32 v61, 4, v121
    v_bfe_u32 v62, v61, 4, 1
    v_lshlrev_b32 v62, 1, v62
    v_and_b32 v63, 7, v61
    v_xor_b32 v62, v62, v63
    v_lshlrev_b32 v62, 4, v62
    v_lshrrev_b32 v61, 3, v61
    v_lshl_add_u32 v61, v61, 10, v62
    v_and_b32 v127, 0x78, v126
    v_mov_b32 v62, 1.0
    v_mov_b32 v63, 0x57800000
    v_mov_b32 v60, 0
    s_waitcnt lgkmcnt(0)
    v_readfirstlane_b32 s48, v124
    v_readfirstlane_b32 s49, v125
    s_nop 0
    s_waitcnt lgkmcnt(0)
    v_exp_f32 v20, v20
    v_exp_f32 v21, v21
    s_mov_b64 exec, s[50:51]
    ds_read_b128 v[108:111], v119 offset:2048
    ds_read_b128 v[112:115], v119 offset:2560
    s_mov_b64 exec, -1
    v_exp_f32 v22, v22
    v_exp_f32 v23, v23
    v_exp_f32 v24, v24
    v_mfma_f32_32x32x16_bf16 v[36:51], v[56:59], v[16:19], 0
    ds_read_b128 v[52:55], v117 offset:4096
    v_exp_f32 v25, v25
    v_exp_f32 v26, v26
    v_exp_f32 v27, v27
    v_exp_f32 v28, v28
    v_exp_f32 v29, v29
    v_smfmac_f32_32x32x32_bf16 v[0:15], v[100:103], v[20:27], v116
    v_exp_f32 v30, v30
    v_exp_f32 v31, v31
    v_exp_f32 v32, v32
    v_exp_f32 v33, v33
    v_exp_f32 v34, v34
    v_exp_f32 v35, v35
    s_cmp_eq_u32 s3, 0
    s_cbranch_scc1 L_pub0
    s_getreg_b32 s53, hwreg(HW_REG_IB_STS)
    s_and_b32 s53, s53, 0xc0000f
    s_cbranch_scc1 L_pub0
L_pubf0:
    v_mov_b32 v122, s48
    v_mov_b32 v123, s49
    s_waitcnt vmcnt(0)
    s_mov_b64 exec, 1
    buffer_store_dwordx2 v[122:123], v60, s[36:39], s61 offen sc1
    s_mov_b64 exec, -1
    s_mov_b32 s3, 0
L_pub0:
    s_waitcnt lgkmcnt(0)
    v_exp_f32 v36, v36
    v_exp_f32 v37, v37
    v_smfmac_f32_32x32x32_bf16 v[0:15], v[104:107], v[28:35], v116
    s_mov_b64 exec, s[50:51]
    ds_read_b128 v[100:103], v119 offset:4096
    ds_read_b128 v[104:107], v119 offset:4608
    s_mov_b64 exec, -1
    v_exp_f32 v38, v38
    v_exp_f32 v39, v39
    v_exp_f32 v40, v40
    v_mfma_f32_32x32x16_bf16 v[20:35], v[52:55], v[16:19], 0
    ds_read_b128 v[56:59], v117 offset:6144
    v_exp_f32 v41, v41
    v_exp_f32 v42, v42
    v_exp_f32 v43, v43
    v_exp_f32 v44, v44
    v_exp_f32 v45, v45
    v_smfmac_f32_32x32x32_bf16 v[0:15], v[108:111], v[36:43], v116
    v_exp_f32 v46, v46
    v_exp_f32 v47, v47
    v_exp_f32 v48, v48
    v_exp_f32 v49, v49
    v_exp_f32 v50, v50
    v_exp_f32 v51, v51
    s_cmp_eq_u32 s3, 0
    s_cbranch_scc1 L_pub1
    s_getreg_b32 s53, hwreg(HW_REG_IB_STS)
    s_and_b32 s53, s53, 0xc0000f
    s_cbranch_scc1 L_pub1
L_pubf1:
    v_mov_b32 v122, s48
    v_mov_b32 v123, s49
    s_waitcnt vmcnt(0)
    s_mov_b64 exec, 1
    buffer_store_dwordx2 v[122:123], v60, s[36:39], s61 offen sc1
    s_mov_b64 exec, -1
    s_mov_b32 s3, 0
L_pub1:
    s_waitcnt lgkmcnt(0)
    v_exp_f32 v20, v20
    v_exp_f32 v21, v21
    v_smfmac_f32_32x32x32_bf16 v[0:15], v[112:115], v[44:51], v116
    s_mov_b64 exec, s[50:51]
    ds_read_b128 v[108:111], v119 offset:6144
    ds_read_b128 v[112:115], v119 offset:6656
    s_mov_b64 exec, -1
    v_exp_f32 v22, v22
    v_exp_f32 v23, v23
    v_exp_f32 v24, v24
    v_mfma_f32_32x32x16_bf16 v[36:51], v[56:59], v[16:19], 0
    ds_read_b128 v[52:55], v117 offset:16384
    v_exp_f32 v25, v25
    v_exp_f32 v26, v26
    v_exp_f32 v27, v27
    v_exp_f32 v28, v28
    v_exp_f32 v29, v29
    v_smfmac_f32_32x32x32_bf16 v[0:15], v[100:103], v[20:27], v116
    v_exp_f32 v30, v30
    v_exp_f32 v31, v31
    v_exp_f32 v32, v32
    v_exp_f32 v33, v33
    v_exp_f32 v34, v34
    v_exp_f32 v35, v35
    s_cmp_eq_u32 s3, 0
    s_cbranch_scc1 L_pub2
    s_getreg_b32 s53, hwreg(HW_REG_IB_STS)
    s_and_b32 s53, s53, 0xc0000f
    s_cbranch_scc1 L_pub2
L_pubf2:
    v_mov_b32 v122, s48
    v_mov_b32 v123, s49
    s_waitcnt vmcnt(0)
    s_mov_b64 exec, 1
    buffer_store_dwordx2 v[122:123], v60, s[36:39], s61 offen sc1
    s_mov_b64 exec, -1
    s_mov_b32 s3, 0
L_pub2:
    s_waitcnt lgkmcnt(0)
    v_exp_f32 v36, v36
    v_exp_f32 v37, v37
    v_smfmac_f32_32x32x32_bf16 v[0:15], v[104:107], v[28:35], v116
    s_mov_b64 exec, s[50:51]
    ds_read_b128 v[100:103], v119 offset:16384
    ds_read_b128 v[104:107], v119 offset:16896
    s_mov_b64 exec, -1
    v_exp_f32 v38, v38
    v_exp_f32 v39, v39
    v_exp_f32 v40, v40
    v_mfma_f32_32x32x16_bf16 v[20:35], v[52:55], v[16:19], 0
    ds_read_b128 v[56:59], v117 offset:18432
    v_exp_f32 v41, v41
    v_exp_f32 v42, v42
    v_exp_f32 v43, v43
    v_exp_f32 v44, v44
    v_exp_f32 v45, v45
    v_smfmac_f32_32x32x32_bf16 v[0:15], v[108:111], v[36:43], v116
    v_exp_f32 v46, v46
    v_exp_f32 v47, v47
    v_exp_f32 v48, v48
    v_exp_f32 v49, v49
    v_exp_f32 v50, v50
    v_exp_f32 v51, v51
    s_cmp_eq_u32 s3, 0
    s_cbranch_scc1 L_pub3
    s_getreg_b32 s53, hwreg(HW_REG_IB_STS)
    s_and_b32 s53, s53, 0xc0000f
    s_cbranch_scc1 L_pub3
L_pubf3:
    v_mov_b32 v122, s48
    v_mov_b32 v123, s49
    s_waitcnt vmcnt(0)
    s_mov_b64 exec, 1
    buffer_store_dwordx2 v[122:123], v60, s[36:39], s61 offen sc1
    s_mov_b64 exec, -1
    s_mov_b32 s3, 0
L_pub3:
    s_sub_u32 s53, s25, 4
    s_cmp_ge_u32 s53, 4
    s_cbranch_scc1 L_nost2
    buffer_store_dwordx4 v[64:67], v96, s[36:39], s55 offen sc1
    buffer_store_dwordx4 v[68:71], v96, s[36:39], s0 offen sc1
    buffer_store_dwordx4 v[72:75], v97, s[36:39], s55 offen sc1
    buffer_store_dwordx4 v[76:79], v97, s[36:39], s55 offen offset:512 sc1
    s_mov_b32 s3, 1
L_nost2:
    s_sub_u32 s52, s25, 8
    s_cmp_ge_u32 s52, 2
    s_cbranch_scc1 L_f1_p
    s_lshr_b32 s63, s52, 1
    s_lshl_b32 s63, s63, 2
    s_lshr_b32 s53, 0x2, s63
    s_and_b32 s53, s53, 15
    s_lshl_b32 s57, s24, 1
    s_xor_b32 s53, s53, s57
    s_lshl_b32 s57, s53, 7
    s_add_u32 s57, s57, s60
    s_mov_b64 exec, 15
    buffer_load_dwordx2 v[122:123], v126, s[36:39], s57 offen sc1
    s_mov_b64 exec, -1
    s_lshl_b32 s53, s53, 14
    s_add_u32 s56, s53, s54
    s_and_b32 s52, s52, 1
    s_mul_i32 s52, s52, 8192
    s_add_u32 s56, s56, s52
    s_lshr_b32 s53, 0x2, s63
    s_and_b32 s53, s53, 15
    s_lshl_b32 s53, s53, 14
    s_add_u32 s52, s52, s53
L_f1_p:
    s_setprio 2
    s_waitcnt lgkmcnt(0)
    v_exp_f32 v20, v20
    v_exp_f32 v21, v21
    v_smfmac_f32_32x32x32_bf16 v[0:15], v[112:115], v[44:51], v116
    s_mov_b64 exec, s[50:51]
    ds_read_b128 v[108:111], v119 offset:18432
    ds_read_b128 v[112:115], v119 offset:18944
    s_mov_b64 exec, -1
    v_exp_f32 v22, v22
    v_exp_f32 v23, v23
    v_exp_f32 v24, v24
    v_mfma_f32_32x32x16_bf16 v[36:51], v[56:59], v[16:19], 0
    ds_read_b128 v[52:55], v117 offset:20480
    v_exp_f32 v25, v25
    v_exp_f32 v26, v26
    v_exp_f32 v27, v27
    v_exp_f32 v28, v28
    v_exp_f32 v29, v29
    v_smfmac_f32_32x32x32_bf16 v[0:15], v[100:103], v[20:27], v116
    v_exp_f32 v30, v30
    v_exp_f32 v31, v31
    v_exp_f32 v32, v32
    v_exp_f32 v33, v33
    v_exp_f32 v34, v34
    v_exp_f32 v35, v35
    s_cmp_eq_u32 s3, 0
    s_cbranch_scc1 L_pub4
    s_getreg_b32 s53, hwreg(HW_REG_IB_STS)
    s_and_b32 s53, s53, 0xc0000f
    s_cbranch_scc1 L_pub4
L_pubf4:
    v_mov_b32 v122, s48
    v_mov_b32 v123, s49
    s_waitcnt vmcnt(0)
    s_mov_b64 exec, 1
    buffer_store_dwordx2 v[122:123], v60, s[36:39], s61 offen sc1
    s_mov_b64 exec, -1
    s_mov_b32 s3, 0
L_pub4:
    s_sub_u32 s53, s25, 8
    s_cmp_ge_u32 s53, 2
    s_cbranch_scc1 L_f1_done
    s_mov_b64 exec, 15
    s_mov_b32 s63, 262144
L_f1_chk:
    s_waitcnt vmcnt(0)
    v_cmp_eq_u64 vcc, s[48:49], v[122:123]
    s_nop 1
    s_cmp_eq_u64 vcc, 15
    s_cbranch_scc1 L_f1_ok
    s_sleep 4
    buffer_load_dwordx2 v[122:123], v126, s[36:39], s57 offen sc1
    s_sub_u32 s63, s63, 1
    s_cmp_lg_u32 s63, 0
    s_cbranch_scc1 L_f1_chk
    s_waitcnt vmcnt(0)
L_f1_ok:
    s_mov_b64 exec, -1
    s_add_u32 m0, s52, 0
    s_add_u32 s53, s56, 0
    buffer_load_dwordx4 v121, s[36:39], s53 offen offset:0 sc1 lds
    buffer_load_dwordx4 v121, s[36:39], s53 offen offset:1024 sc1 lds
    buffer_load_dwordx4 v121, s[36:39], s53 offen offset:2048 sc1 lds
    buffer_load_dwordx4 v121, s[36:39], s53 offen offset:3072 sc1 lds
    s_add_u32 m0, s52, 4096
    s_add_u32 s53, s56, 4096
    buffer_load_dwordx4 v121, s[36:39], s53 offen offset:0 sc1 lds
    buffer_load_dwordx4 v121, s[36:39], s53 offen offset:1024 sc1 lds
    buffer_load_dwordx4 v121, s[36:39], s53 offen offset:2048 sc1 lds
    buffer_load_dwordx4 v121, s[36:39], s53 offen offset:3072 sc1 lds
L_f1_done:
    s_waitcnt lgkmcnt(0)
    v_exp_f32 v36, v36
    v_exp_f32 v37, v37
    v_smfmac_f32_32x32x32_bf16 v[0:15], v[104:107], v[28:35], v116
    s_mov_b64 exec, s[50:51]
    ds_read_b128 v[100:103], v119 offset:20480
    ds_read_b128 v[104:107], v119 offset:20992
    s_mov_b64 exec, -1
    v_exp_f32 v38, v38
    v_exp_f32 v39, v39
    v_exp_f32 v40, v40
    v_mfma_f32_32x32x16_bf16 v[20:35], v[52:55], v[16:19], 0
    ds_read_b128 v[56:59], v117 offset:22528
    v_exp_f32 v41, v41
    v_exp_f32 v42, v42
    v_exp_f32 v43, v43
    v_exp_f32 v44, v44
    v_exp_f32 v45, v45
    v_smfmac_f32_32x32x32_bf16 v[0:15], v[108:111], v[36:43], v116
    v_exp_f32 v46, v46
    v_exp_f32 v47, v47
    v_exp_f32 v48, v48
    v_exp_f32 v49, v49
    v_exp_f32 v50, v50
    v_exp_f32 v51, v51
    s_cmp_eq_u32 s3, 0
    s_cbranch_scc1 L_pub5
    s_getreg_b32 s53, hwreg(HW_REG_IB_STS)
    s_and_b32 s53, s53, 0xc0000f
    s_cbranch_scc1 L_pub5
L_pubf5:
    v_mov_b32 v122, s48
    v_mov_b32 v123, s49
    s_waitcnt vmcnt(0)
    s_mov_b64 exec, 1
    buffer_store_dwordx2 v[122:123], v60, s[36:39], s61 offen sc1
    s_mov_b64 exec, -1
    s_mov_b32 s3, 0
L_pub5:
    s_setprio 1
    s_waitcnt lgkmcnt(0)
    v_exp_f32 v20, v20
    v_exp_f32 v21, v21
    v_smfmac_f32_32x32x32_bf16 v[0:15], v[112:115], v[44:51], v116
    s_mov_b64 exec, s[50:51]
    ds_read_b128 v[108:111], v119 offset:22528
    ds_read_b128 v[112:115], v119 offset:23040
    s_mov_b64 exec, -1
    v_exp_f32 v22, v22
    v_exp_f32 v23, v23
    v_exp_f32 v24, v24
    v_mfma_f32_32x32x16_bf16 v[36:51], v[56:59], v[16:19], 0
    v_exp_f32 v25, v25
    v_exp_f32 v26, v26
    v_exp_f32 v27, v27
    v_exp_f32 v28, v28
    v_exp_f32 v29, v29
    v_smfmac_f32_32x32x32_bf16 v[0:15], v[100:103], v[20:27], v116
    v_exp_f32 v30, v30
    v_exp_f32 v31, v31
    v_exp_f32 v32, v32
    v_exp_f32 v33, v33
    v_exp_f32 v34, v34
    v_exp_f32 v35, v35
    s_cmp_eq_u32 s3, 0
    s_cbranch_scc1 L_pub6
    s_getreg_b32 s53, hwreg(HW_REG_IB_STS)
    s_and_b32 s53, s53, 0xc0000f
    s_cbranch_scc1 L_pub6
L_pubf6:
    v_mov_b32 v122, s48
    v_mov_b32 v123, s49
    s_waitcnt vmcnt(0)
    s_mov_b64 exec, 1
    buffer_store_dwordx2 v[122:123], v60, s[36:39], s61 offen sc1
    s_mov_b64 exec, -1
    s_mov_b32 s3, 0
L_pub6:
    s_sub_u32 s52, s25, 10
    s_cmp_ge_u32 s52, 4
    s_cbranch_scc1 L_f2_p
    s_lshr_b32 s63, s52, 1
    s_lshl_b32 s63, s63, 2
    s_lshr_b32 s53, 0x64, s63
    s_and_b32 s53, s53, 15
    s_lshl_b32 s57, s24, 1
    s_xor_b32 s53, s53, s57
    s_lshl_b32 s57, s53, 7
    s_add_u32 s57, s57, s60
    s_mov_b64 exec, 15
    buffer_load_dwordx2 v[122:123], v126, s[36:39], s57 offen sc1
    s_mov_b64 exec, -1
    s_lshl_b32 s53, s53, 14
    s_add_u32 s56, s53, s54
    s_and_b32 s52, s52, 1
    s_mul_i32 s52, s52, 8192
    s_add_u32 s56, s56, s52
    s_lshr_b32 s53, 0x43, s63
    s_and_b32 s53, s53, 15
    s_lshl_b32 s53, s53, 14
    s_add_u32 s52, s52, s53
L_f2_p:
    s_setprio 0
    s_waitcnt lgkmcnt(0)
    v_exp_f32 v36, v36
    v_exp_f32 v37, v37
    v_smfmac_f32_32x32x32_bf16 v[0:15], v[104:107], v[28:35], v116
    v_exp_f32 v38, v38
    v_exp_f32 v39, v39
    v_exp_f32 v40, v40
    v_exp_f32 v41, v41
    v_exp_f32 v42, v42
    v_exp_f32 v43, v43
    v_exp_f32 v44, v44
    v_exp_f32 v45, v45
    v_smfmac_f32_32x32x32_bf16 v[0:15], v[108:111], v[36:43], v116
    v_exp_f32 v46, v46
    v_exp_f32 v47, v47
    v_exp_f32 v48, v48
    v_exp_f32 v49, v49
    v_exp_f32 v50, v50
    v_exp_f32 v51, v51
    s_cmp_eq_u32 s3, 0
    s_cbranch_scc1 L_pub7
    s_cmp_lt_u32 s25, 4
    s_cbranch_scc1 L_pubf7
    s_getreg_b32 s53, hwreg(HW_REG_IB_STS)
    s_and_b32 s53, s53, 0xc0000f
    s_cbranch_scc1 L_pub7
L_pubf7:
    v_mov_b32 v122, s48
    v_mov_b32 v123, s49
    s_waitcnt vmcnt(0)
    s_mov_b64 exec, 1
    buffer_store_dwordx2 v[122:123], v60, s[36:39], s61 offen sc1
    s_mov_b64 exec, -1
    s_mov_b32 s3, 0
L_pub7:
    s_cmp_lt_u32 s25, 8
    s_cbranch_scc1 L_b7
    s_waitcnt vmcnt(0)
L_b7:
    s_barrier
    s_setprio 3
    ds_read_b128 v[52:55], v117 offset:32768
    ds_read_b128 v[56:59], v117 offset:34816
    s_mov_b64 exec, s[50:51]
    ds_read_b128 v[100:103], v119 offset:32768
    ds_read_b128 v[104:107], v119 offset:33280
    s_mov_b64 exec, -1
    s_waitcnt lgkmcnt(3)
    v_mfma_f32_32x32x16_bf16 v[20:35], v[52:55], v[16:19], 0
    s_nop 10
    s_sub_u32 s53, s25, 10
    s_cmp_ge_u32 s53, 4
    s_cbranch_scc1 L_f2_done
    s_mov_b64 exec, 15
    s_mov_b32 s63, 262144
L_f2_chk:
    s_waitcnt vmcnt(0)
    v_cmp_eq_u64 vcc, s[48:49], v[122:123]
    s_nop 1
    s_cmp_eq_u64 vcc, 15
    s_cbranch_scc1 L_f2_ok
    s_sleep 4
    buffer_load_dwordx2 v[122:123], v126, s[36:39], s57 offen sc1
    s_sub_u32 s63, s63, 1
    s_cmp_lg_u32 s63, 0
    s_cbranch_scc1 L_f2_chk
    s_waitcnt vmcnt(0)
L_f2_ok:
    s_mov_b64 exec, -1
    s_add_u32 m0, s52, 0
    s_add_u32 s53, s56, 0
    buffer_load_dwordx4 v121, s[36:39], s53 offen offset:0 sc1 lds
    buffer_load_dwordx4 v121, s[36:39], s53 offen offset:1024 sc1 lds
    buffer_load_dwordx4 v121, s[36:39], s53 offen offset:2048 sc1 lds
    buffer_load_dwordx4 v121, s[36:39], s53 offen offset:3072 sc1 lds
    s_add_u32 m0, s52, 4096
    s_add_u32 s53, s56, 4096
    buffer_load_dwordx4 v121, s[36:39], s53 offen offset:0 sc1 lds
    buffer_load_dwordx4 v121, s[36:39], s53 offen offset:1024 sc1 lds
    buffer_load_dwordx4 v121, s[36:39], s53 offen offset:2048 sc1 lds
    buffer_load_dwordx4 v121, s[36:39], s53 offen offset:3072 sc1 lds
L_f2_done:
    s_waitcnt lgkmcnt(0)
    v_exp_f32 v20, v20
    v_exp_f32 v21, v21
    v_smfmac_f32_32x32x32_bf16 v[0:15], v[112:115], v[44:51], v116
    s_mov_b64 exec, s[50:51]
    ds_read_b128 v[108:111], v119 offset:34816
    ds_read_b128 v[112:115], v119 offset:35328
    s_mov_b64 exec, -1
    v_exp_f32 v22, v22
    v_exp_f32 v23, v23
    v_exp_f32 v24, v24
    v_mfma_f32_32x32x16_bf16 v[36:51], v[56:59], v[16:19], 0
    ds_read_b128 v[52:55], v117 offset:36864
    v_exp_f32 v25, v25
    v_exp_f32 v26, v26
    v_exp_f32 v27, v27
    v_exp_f32 v28, v28
    v_exp_f32 v29, v29
    v_smfmac_f32_32x32x32_bf16 v[0:15], v[100:103], v[20:27], v116
    v_exp_f32 v30, v30
    v_exp_f32 v31, v31
    v_exp_f32 v32, v32
    v_exp_f32 v33, v33
    v_exp_f32 v34, v34
    v_exp_f32 v35, v35
    s_cmp_eq_u32 s3, 0
    s_cbranch_scc1 L_pub8
    s_getreg_b32 s53, hwreg(HW_REG_IB_STS)
    s_and_b32 s53, s53, 0xc0000f
    s_cbranch_scc1 L_pub8
L_pubf8:
    v_mov_b32 v122, s48
    v_mov_b32 v123, s49
    s_waitcnt vmcnt(0)
    s_mov_b64 exec, 1
    buffer_store_dwordx2 v[122:123], v60, s[36:39], s61 offen sc1
    s_mov_b64 exec, -1
    s_mov_b32 s3, 0
L_pub8:
    s_waitcnt lgkmcnt(0)
    v_exp_f32 v36, v36
    v_exp_f32 v37, v37
    v_smfmac_f32_32x32x32_bf16 v[0:15], v[104:107], v[28:35], v116
    s_mov_b64 exec, s[50:51]
    ds_read_b128 v[100:103], v119 offset:36864
    ds_read_b128 v[104:107], v119 offset:37376
    s_mov_b64 exec, -1
    v_exp_f32 v38, v38
    v_exp_f32 v39, v39
    v_exp_f32 v40, v40
    v_mfma_f32_32x32x16_bf16 v[20:35], v[52:55], v[16:19], 0
    ds_read_b128 v[56:59], v117 offset:38912
    v_exp_f32 v41, v41
    v_exp_f32 v42, v42
    v_exp_f32 v43, v43
    v_exp_f32 v44, v44
    v_exp_f32 v45, v45
    v_smfmac_f32_32x32x32_bf16 v[0:15], v[108:111], v[36:43], v116
    v_exp_f32 v46, v46
    v_exp_f32 v47, v47
    v_exp_f32 v48, v48
    v_exp_f32 v49, v49
    v_exp_f32 v50, v50
    v_exp_f32 v51, v51
    s_cmp_eq_u32 s3, 0
    s_cbranch_scc1 L_pub9
    s_getreg_b32 s53, hwreg(HW_REG_IB_STS)
    s_and_b32 s53, s53, 0xc0000f
    s_cbranch_scc1 L_pub9
L_pubf9:
    v_mov_b32 v122, s48
    v_mov_b32 v123, s49
    s_waitcnt vmcnt(0)
    s_mov_b64 exec, 1
    buffer_store_dwordx2 v[122:123], v60, s[36:39], s61 offen sc1
    s_mov_b64 exec, -1
    s_mov_b32 s3, 0
L_pub9:
    s_setprio 1
    s_waitcnt lgkmcnt(0)
    v_exp_f32 v20, v20
    v_exp_f32 v21, v21
    v_smfmac_f32_32x32x32_bf16 v[0:15], v[112:115], v[44:51], v116
    s_mov_b64 exec, s[50:51]
    ds_read_b128 v[108:111], v119 offset:38912
    ds_read_b128 v[112:115], v119 offset:39424
    s_mov_b64 exec, -1
    v_exp_f32 v22, v22
    v_exp_f32 v23, v23
    v_exp_f32 v24, v24
    v_mfma_f32_32x32x16_bf16 v[36:51], v[56:59], v[16:19], 0
    s_cmp_lt_u32 s25, 8
    s_cbranch_scc1 L_b10
    s_waitcnt vmcnt(0)
L_b10:
    s_barrier
    s_setprio 3
    ds_read_b128 v[52:55], v117 offset:49152
    v_exp_f32 v25, v25
    v_exp_f32 v26, v26
    v_exp_f32 v27, v27
    v_exp_f32 v28, v28
    v_exp_f32 v29, v29
    v_smfmac_f32_32x32x32_bf16 v[0:15], v[100:103], v[20:27], v116
    v_exp_f32 v30, v30
    v_exp_f32 v31, v31
    v_exp_f32 v32, v32
    v_exp_f32 v33, v33
    v_exp_f32 v34, v34
    v_exp_f32 v35, v35
    s_cmp_eq_u32 s3, 0
    s_cbranch_scc1 L_pub10
    s_getreg_b32 s53, hwreg(HW_REG_IB_STS)
    s_and_b32 s53, s53, 0xc0000f
    s_cbranch_scc1 L_pub10
L_pubf10:
    v_mov_b32 v122, s48
    v_mov_b32 v123, s49
    s_waitcnt vmcnt(0)
    s_mov_b64 exec, 1
    buffer_store_dwordx2 v[122:123], v60, s[36:39], s61 offen sc1
    s_mov_b64 exec, -1
    s_mov_b32 s3, 0
L_pub10:
    s_setprio 3
    s_waitcnt lgkmcnt(0)
    v_exp_f32 v36, v36
    v_exp_f32 v37, v37
    v_smfmac_f32_32x32x32_bf16 v[0:15], v[104:107], v[28:35], v116
    s_mov_b64 exec, s[50:51]
    ds_read_b128 v[100:103], v119 offset:49152
    ds_read_b128 v[104:107], v119 offset:49664
    s_mov_b64 exec, -1
    v_exp_f32 v38, v38
    v_exp_f32 v39, v39
    v_exp_f32 v40, v40
    v_mfma_f32_32x32x16_bf16 v[20:35], v[52:55], v[16:19], 0
    ds_read_b128 v[56:59], v117 offset:51200
    v_exp_f32 v41, v41
    v_exp_f32 v42, v42
    v_exp_f32 v43, v43
    v_exp_f32 v44, v44
    v_exp_f32 v45, v45
    v_smfmac_f32_32x32x32_bf16 v[0:15], v[108:111], v[36:43], v116
    v_exp_f32 v46, v46
    v_exp_f32 v47, v47
    v_exp_f32 v48, v48
    v_exp_f32 v49, v49
    v_exp_f32 v50, v50
    v_exp_f32 v51, v51
    s_cmp_eq_u32 s3, 0
    s_cbranch_scc1 L_pub11
    s_getreg_b32 s53, hwreg(HW_REG_IB_STS)
    s_and_b32 s53, s53, 0xc0000f
    s_cbranch_scc1 L_pub11
L_pubf11:
    v_mov_b32 v122, s48
    v_mov_b32 v123, s49
    s_waitcnt vmcnt(0)
    s_mov_b64 exec, 1
    buffer_store_dwordx2 v[122:123], v60, s[36:39], s61 offen sc1
    s_mov_b64 exec, -1
    s_mov_b32 s3, 0
L_pub11:
    s_sub_u32 s52, s25, 8
    s_cmp_ge_u32 s52, 8
    s_cbranch_scc1 L_f3_p
    s_lshr_b32 s63, s52, 1
    s_lshl_b32 s63, s63, 2
    s_lshr_b32 s53, 0xeca8, s63
    s_and_b32 s53, s53, 15
    s_lshl_b32 s57, s24, 1
    s_xor_b32 s53, s53, s57
    s_lshl_b32 s57, s53, 7
    s_add_u32 s57, s57, s60
    s_mov_b64 exec, 15
    buffer_load_dwordx2 v[122:123], v126, s[36:39], s57 offen sc1
    s_mov_b64 exec, -1
    s_lshl_b32 s53, s53, 14
    s_add_u32 s56, s53, s54
    s_and_b32 s52, s52, 1
    s_mul_i32 s52, s52, 8192
    s_add_u32 s56, s56, s52
    s_lshr_b32 s53, 0x8765, s63
    s_and_b32 s53, s53, 15
    s_lshl_b32 s53, s53, 14
    s_add_u32 s52, s52, s53
L_f3_p:
    s_waitcnt lgkmcnt(0)
    v_exp_f32 v20, v20
    v_exp_f32 v21, v21
    v_smfmac_f32_32x32x32_bf16 v[0:15], v[112:115], v[44:51], v116
    s_mov_b64 exec, s[50:51]
    ds_read_b128 v[108:111], v119 offset:51200
    ds_read_b128 v[112:115], v119 offset:51712
    s_mov_b64 exec, -1
    v_exp_f32 v22, v22
    v_exp_f32 v23, v23
    v_exp_f32 v24, v24
    v_mfma_f32_32x32x16_bf16 v[36:51], v[56:59], v[16:19], 0
    ds_read_b128 v[52:55], v117 offset:53248
    v_exp_f32 v25, v25
    v_exp_f32 v26, v26
    v_exp_f32 v27, v27
    v_exp_f32 v28, v28
    v_exp_f32 v29, v29
    v_smfmac_f32_32x32x32_bf16 v[0:15], v[100:103], v[20:27], v116
    v_exp_f32 v30, v30
    v_exp_f32 v31, v31
    v_exp_f32 v32, v32
    v_exp_f32 v33, v33
    v_exp_f32 v34, v34
    v_exp_f32 v35, v35
    s_cmp_eq_u32 s3, 0
    s_cbranch_scc1 L_pub12
    s_getreg_b32 s53, hwreg(HW_REG_IB_STS)
    s_and_b32 s53, s53, 0xc0000f
    s_cbranch_scc1 L_pub12
L_pubf12:
    v_mov_b32 v122, s48
    v_mov_b32 v123, s49
    s_waitcnt vmcnt(0)
    s_mov_b64 exec, 1
    buffer_store_dwordx2 v[122:123], v60, s[36:39], s61 offen sc1
    s_mov_b64 exec, -1
    s_mov_b32 s3, 0
L_pub12:
    s_sub_u32 s53, s25, 8
    s_cmp_ge_u32 s53, 8
    s_cbranch_scc1 L_f3_done
    s_mov_b64 exec, 15
    s_mov_b32 s63, 262144
L_f3_chk:
    s_waitcnt vmcnt(0)
    v_cmp_eq_u64 vcc, s[48:49], v[122:123]
    s_nop 1
    s_cmp_eq_u64 vcc, 15
    s_cbranch_scc1 L_f3_ok
    s_sleep 4
    buffer_load_dwordx2 v[122:123], v126, s[36:39], s57 offen sc1
    s_sub_u32 s63, s63, 1
    s_cmp_lg_u32 s63, 0
    s_cbranch_scc1 L_f3_chk
    s_waitcnt vmcnt(0)
L_f3_ok:
    s_mov_b64 exec, -1
    s_add_u32 m0, s52, 0
    s_add_u32 s53, s56, 0
    buffer_load_dwordx4 v121, s[36:39], s53 offen offset:0 sc1 lds
    buffer_load_dwordx4 v121, s[36:39], s53 offen offset:1024 sc1 lds
    buffer_load_dwordx4 v121, s[36:39], s53 offen offset:2048 sc1 lds
    buffer_load_dwordx4 v121, s[36:39], s53 offen offset:3072 sc1 lds
    s_add_u32 m0, s52, 4096
    s_add_u32 s53, s56, 4096
    buffer_load_dwordx4 v121, s[36:39], s53 offen offset:0 sc1 lds
    buffer_load_dwordx4 v121, s[36:39], s53 offen offset:1024 sc1 lds
    buffer_load_dwordx4 v121, s[36:39], s53 offen offset:2048 sc1 lds
    buffer_load_dwordx4 v121, s[36:39], s53 offen offset:3072 sc1 lds
L_f3_done:
    s_waitcnt lgkmcnt(0)
    v_exp_f32 v36, v36
    v_exp_f32 v37, v37
    v_smfmac_f32_32x32x32_bf16 v[0:15], v[104:107], v[28:35], v116
    s_mov_b64 exec, s[50:51]
    ds_read_b128 v[100:103], v119 offset:53248
    ds_read_b128 v[104:107], v119 offset:53760
    s_mov_b64 exec, -1
    v_exp_f32 v38, v38
    v_exp_f32 v39, v39
    v_exp_f32 v40, v40
    v_mfma_f32_32x32x16_bf16 v[20:35], v[52:55], v[16:19], 0
    ds_read_b128 v[56:59], v117 offset:55296
    v_exp_f32 v41, v41
    v_exp_f32 v42, v42
    v_exp_f32 v43, v43
    v_exp_f32 v44, v44
    v_exp_f32 v45, v45
    v_smfmac_f32_32x32x32_bf16 v[0:15], v[108:111], v[36:43], v116
    v_exp_f32 v46, v46
    v_exp_f32 v47, v47
    v_exp_f32 v48, v48
    v_exp_f32 v49, v49
    v_exp_f32 v50, v50
    v_exp_f32 v51, v51
    s_cmp_eq_u32 s3, 0
    s_cbranch_scc1 L_pub13
    s_getreg_b32 s53, hwreg(HW_REG_IB_STS)
    s_and_b32 s53, s53, 0xc0000f
    s_cbranch_scc1 L_pub13
L_pubf13:
    v_mov_b32 v122, s48
    v_mov_b32 v123, s49
    s_waitcnt vmcnt(0)
    s_mov_b64 exec, 1
    buffer_store_dwordx2 v[122:123], v60, s[36:39], s61 offen sc1
    s_mov_b64 exec, -1
    s_mov_b32 s3, 0
L_pub13:
    s_setprio 2
    s_waitcnt lgkmcnt(0)
    v_exp_f32 v20, v20
    v_exp_f32 v21, v21
    v_smfmac_f32_32x32x32_bf16 v[0:15], v[112:115], v[44:51], v116
    s_mov_b64 exec, s[50:51]
    ds_read_b128 v[108:111], v119 offset:55296
    ds_read_b128 v[112:115], v119 offset:55808
    s_mov_b64 exec, -1
    v_exp_f32 v22, v22
    v_exp_f32 v23, v23
    v_exp_f32 v24, v24
    v_mfma_f32_32x32x16_bf16 v[36:51], v[56:59], v[16:19], 0
    ds_read_b128 v[52:55], v118 offset:0
    v_exp_f32 v25, v25
    v_exp_f32 v26, v26
    v_exp_f32 v27, v27
    v_exp_f32 v28, v28
    v_exp_f32 v29, v29
    v_smfmac_f32_32x32x32_bf16 v[0:15], v[100:103], v[20:27], v116
    v_exp_f32 v30, v30
    v_exp_f32 v31, v31
    v_exp_f32 v32, v32
    v_exp_f32 v33, v33
    v_exp_f32 v34, v34
    v_exp_f32 v35, v35
    s_cmp_eq_u32 s3, 0
    s_cbranch_scc1 L_pub14
    s_getreg_b32 s53, hwreg(HW_REG_IB_STS)
    s_and_b32 s53, s53, 0xc0000f
    s_cbranch_scc1 L_pub14
L_pubf14:
    v_mov_b32 v122, s48
    v_mov_b32 v123, s49
    s_waitcnt vmcnt(0)
    s_mov_b64 exec, 1
    buffer_store_dwordx2 v[122:123], v60, s[36:39], s61 offen sc1
    s_mov_b64 exec, -1
    s_mov_b32 s3, 0
L_pub14:
    s_waitcnt lgkmcnt(0)
    v_exp_f32 v36, v36
    v_exp_f32 v37, v37
    v_smfmac_f32_32x32x32_bf16 v[0:15], v[104:107], v[28:35], v116
    s_mov_b64 exec, s[50:51]
    ds_read_b128 v[100:103], v120 offset:0
    ds_read_b128 v[104:107], v120 offset:512
    s_mov_b64 exec, -1
    v_exp_f32 v38, v38
    v_exp_f32 v39, v39
    v_exp_f32 v40, v40
    v_mfma_f32_32x32x16_bf16 v[20:35], v[52:55], v[16:19], 0
    ds_read_b128 v[56:59], v118 offset:2048
    v_exp_f32 v41, v41
    v_exp_f32 v42, v42
    v_exp_f32 v43, v43
    v_exp_f32 v44, v44
    v_exp_f32 v45, v45
    v_smfmac_f32_32x32x32_bf16 v[0:15], v[108:111], v[36:43], v116
    v_exp_f32 v46, v46
    v_exp_f32 v47, v47
    v_exp_f32 v48, v48
    v_exp_f32 v49, v49
    v_exp_f32 v50, v50
    v_exp_f32 v51, v51
    s_cmp_eq_u32 s3, 0
    s_cbranch_scc1 L_pub15
    s_getreg_b32 s53, hwreg(HW_REG_IB_STS)
    s_and_b32 s53, s53, 0xc0000f
    s_cbranch_scc1 L_pub15
L_pubf15:
    v_mov_b32 v122, s48
    v_mov_b32 v123, s49
    s_waitcnt vmcnt(0)
    s_mov_b64 exec, 1
    buffer_store_dwordx2 v[122:123], v60, s[36:39], s61 offen sc1
    s_mov_b64 exec, -1
    s_mov_b32 s3, 0
L_pub15:
    s_waitcnt lgkmcnt(0)
    v_exp_f32 v20, v20
    v_exp_f32 v21, v21
    v_smfmac_f32_32x32x32_bf16 v[0:15], v[112:115], v[44:51], v116
    s_mov_b64 exec, s[50:51]
    ds_read_b128 v[108:111], v120 offset:2048
    ds_read_b128 v[112:115], v120 offset:2560
    s_mov_b64 exec, -1
    v_exp_f32 v22, v22
    v_exp_f32 v23, v23
    v_exp_f32 v24, v24
    v_mfma_f32_32x32x16_bf16 v[36:51], v[56:59], v[16:19], 0
    ds_read_b128 v[52:55], v118 offset:4096
    v_exp_f32 v25, v25
    v_exp_f32 v26, v26
    v_exp_f32 v27, v27
    v_exp_f32 v28, v28
    v_exp_f32 v29, v29
    v_smfmac_f32_32x32x32_bf16 v[0:15], v[100:103], v[20:27], v116
    v_exp_f32 v30, v30
    v_exp_f32 v31, v31
    v_exp_f32 v32, v32
    v_exp_f32 v33, v33
    v_exp_f32 v34, v34
    v_exp_f32 v35, v35
    s_cmp_eq_u32 s3, 0
    s_cbranch_scc1 L_pub16
L_pubf16:
    v_mov_b32 v122, s48
    v_mov_b32 v123, s49
    s_waitcnt vmcnt(0)
    s_mov_b64 exec, 1
    buffer_store_dwordx2 v[122:123], v60, s[36:39], s61 offen sc1
    s_mov_b64 exec, -1
    s_mov_b32 s3, 0
L_pub16:
    s_setprio 1
    s_waitcnt lgkmcnt(0)
    v_exp_f32 v36, v36
    v_exp_f32 v37, v37
    v_smfmac_f32_32x32x32_bf16 v[0:15], v[104:107], v[28:35], v116
    s_mov_b64 exec, s[50:51]
    ds_read_b128 v[100:103], v120 offset:4096
    ds_read_b128 v[104:107], v120 offset:4608
    s_mov_b64 exec, -1
    v_exp_f32 v38, v38
    v_exp_f32 v39, v39
    v_exp_f32 v40, v40
    v_mfma_f32_32x32x16_bf16 v[20:35], v[52:55], v[16:19], 0
    ds_read_b128 v[56:59], v118 offset:6144
    v_exp_f32 v41, v41
    v_exp_f32 v42, v42
    v_exp_f32 v43, v43
    v_exp_f32 v44, v44
    v_exp_f32 v45, v45
    v_smfmac_f32_32x32x32_bf16 v[0:15], v[108:111], v[36:43], v116
    v_exp_f32 v46, v46
    v_exp_f32 v47, v47
    v_exp_f32 v48, v48
    v_exp_f32 v49, v49
    v_exp_f32 v50, v50
    v_exp_f32 v51, v51
    s_setprio 0
    s_waitcnt lgkmcnt(0)
    v_exp_f32 v20, v20
    v_exp_f32 v21, v21
    v_smfmac_f32_32x32x32_bf16 v[0:15], v[112:115], v[44:51], v116
    s_mov_b64 exec, s[50:51]
    ds_read_b128 v[108:111], v120 offset:6144
    ds_read_b128 v[112:115], v120 offset:6656
    s_mov_b64 exec, -1
    v_exp_f32 v22, v22
    v_exp_f32 v23, v23
    v_exp_f32 v24, v24
    v_mfma_f32_32x32x16_bf16 v[36:51], v[56:59], v[16:19], 0
    s_cmp_lt_u32 s25, 8
    s_cbranch_scc1 L_b18
    s_waitcnt vmcnt(0)
L_b18:
    s_barrier
    s_setprio 3
    ds_read_b128 v[52:55], v118 offset:16384
    v_exp_f32 v25, v25
    v_exp_f32 v26, v26
    v_exp_f32 v27, v27
    v_exp_f32 v28, v28
    v_exp_f32 v29, v29
    v_smfmac_f32_32x32x32_bf16 v[0:15], v[100:103], v[20:27], v116
    v_exp_f32 v30, v30
    v_exp_f32 v31, v31
    v_exp_f32 v32, v32
    v_exp_f32 v33, v33
    v_exp_f32 v34, v34
    v_exp_f32 v35, v35
    s_waitcnt lgkmcnt(0)
    v_exp_f32 v36, v36
    v_exp_f32 v37, v37
    v_smfmac_f32_32x32x32_bf16 v[0:15], v[104:107], v[28:35], v116
    s_mov_b64 exec, s[50:51]
    ds_read_b128 v[100:103], v120 offset:16384
    ds_read_b128 v[104:107], v120 offset:16896
    s_mov_b64 exec, -1
    v_exp_f32 v38, v38
    v_exp_f32 v39, v39
    v_exp_f32 v40, v40
    v_mfma_f32_32x32x16_bf16 v[20:35], v[52:55], v[16:19], 0
    ds_read_b128 v[56:59], v118 offset:18432
    v_exp_f32 v41, v41
    v_exp_f32 v42, v42
    v_exp_f32 v43, v43
    v_exp_f32 v44, v44
    v_exp_f32 v45, v45
    v_smfmac_f32_32x32x32_bf16 v[0:15], v[108:111], v[36:43], v116
    v_exp_f32 v46, v46
    v_exp_f32 v47, v47
    v_exp_f32 v48, v48
    v_exp_f32 v49, v49
    v_exp_f32 v50, v50
    v_exp_f32 v51, v51
    s_cmp_lg_u32 s25, 0
    s_cbranch_scc1 L_xid
    v_mov_b32 v122, s48
    v_mov_b32 v123, s49
    v_or_b32 v122, s26, v122
    s_lshl_b32 s53, s23, 3
    s_add_u32 s53, s53, s10
    s_mov_b64 exec, 1
    buffer_store_dwordx2 v[122:123], v60, s[36:39], s53 offen sc1
    s_mov_b64 exec, -1
L_xid:
    s_sub_u32 s52, s25, 8
    s_cmp_ge_u32 s52, 5
    s_cbranch_scc1 L_f4_p
    s_lshr_b32 s63, s52, 0
    s_lshl_b32 s63, s63, 2
    s_lshr_b32 s53, 0xb9753, s63
    s_and_b32 s53, s53, 15
    s_lshl_b32 s57, s24, 1
    s_xor_b32 s53, s53, s57
    s_lshl_b32 s57, s53, 7
    s_add_u32 s57, s57, s60
    s_mov_b64 exec, 15
    buffer_load_dwordx2 v[122:123], v126, s[36:39], s57 offen sc1
    s_mov_b64 exec, -1
    s_lshl_b32 s53, s53, 14
    s_add_u32 s56, s53, s54
    s_and_b32 s52, s52, 0
    s_mul_i32 s52, s52, 16384
    s_add_u32 s56, s56, s52
    s_lshr_b32 s53, 0x32109, s63
    s_and_b32 s53, s53, 15
    s_lshl_b32 s53, s53, 14
    s_add_u32 s52, s52, s53
L_f4_p:
    s_waitcnt lgkmcnt(0)
    v_exp_f32 v20, v20
    v_exp_f32 v21, v21
    v_smfmac_f32_32x32x32_bf16 v[0:15], v[112:115], v[44:51], v116
    s_mov_b64 exec, s[50:51]
    ds_read_b128 v[108:111], v120 offset:18432
    ds_read_b128 v[112:115], v120 offset:18944
    s_mov_b64 exec, -1
    v_exp_f32 v22, v22
    v_exp_f32 v23, v23
    v_exp_f32 v24, v24
    v_mfma_f32_32x32x16_bf16 v[36:51], v[56:59], v[16:19], 0
    ds_read_b128 v[52:55], v118 offset:20480
    v_exp_f32 v25, v25
    v_exp_f32 v26, v26
    v_exp_f32 v27, v27
    v_exp_f32 v28, v28
    v_exp_f32 v29, v29
    v_smfmac_f32_32x32x32_bf16 v[0:15], v[100:103], v[20:27], v116
    v_exp_f32 v30, v30
    v_exp_f32 v31, v31
    v_exp_f32 v32, v32
    v_exp_f32 v33, v33
    v_exp_f32 v34, v34
    v_exp_f32 v35, v35
    s_sub_u32 s53, s25, 8
    s_cmp_ge_u32 s53, 5
    s_cbranch_scc1 L_f4_done
    s_mov_b64 exec, 15
    s_mov_b32 s63, 262144
L_f4_chk:
    s_waitcnt vmcnt(0)
    v_cmp_eq_u64 vcc, s[48:49], v[122:123]
    s_nop 1
    s_cmp_eq_u64 vcc, 15
    s_cbranch_scc1 L_f4_ok
    s_sleep 4
    buffer_load_dwordx2 v[122:123], v126, s[36:39], s57 offen sc1
    s_sub_u32 s63, s63, 1
    s_cmp_lg_u32 s63, 0
    s_cbranch_scc1 L_f4_chk
    s_waitcnt vmcnt(0)
L_f4_ok:
    s_mov_b64 exec, -1
    s_add_u32 m0, s52, 0
    s_add_u32 s53, s56, 0
    buffer_load_dwordx4 v121, s[36:39], s53 offen offset:0 sc1 lds
    buffer_load_dwordx4 v121, s[36:39], s53 offen offset:1024 sc1 lds
    buffer_load_dwordx4 v121, s[36:39], s53 offen offset:2048 sc1 lds
    buffer_load_dwordx4 v121, s[36:39], s53 offen offset:3072 sc1 lds
    s_add_u32 m0, s52, 4096
    s_add_u32 s53, s56, 4096
    buffer_load_dwordx4 v121, s[36:39], s53 offen offset:0 sc1 lds
    buffer_load_dwordx4 v121, s[36:39], s53 offen offset:1024 sc1 lds
    buffer_load_dwordx4 v121, s[36:39], s53 offen offset:2048 sc1 lds
    buffer_load_dwordx4 v121, s[36:39], s53 offen offset:3072 sc1 lds
    s_add_u32 m0, s52, 8192
    s_add_u32 s53, s56, 8192
    buffer_load_dwordx4 v121, s[36:39], s53 offen offset:0 sc1 lds
    buffer_load_dwordx4 v121, s[36:39], s53 offen offset:1024 sc1 lds
    buffer_load_dwordx4 v121, s[36:39], s53 offen offset:2048 sc1 lds
    buffer_load_dwordx4 v121, s[36:39], s53 offen offset:3072 sc1 lds
    s_add_u32 m0, s52, 12288
    s_add_u32 s53, s56, 12288
    buffer_load_dwordx4 v121, s[36:39], s53 offen offset:0 sc1 lds
    buffer_load_dwordx4 v121, s[36:39], s53 offen offset:1024 sc1 lds
    buffer_load_dwordx4 v121, s[36:39], s53 offen offset:2048 sc1 lds
    buffer_load_dwordx4 v121, s[36:39], s53 offen offset:3072 sc1 lds
L_f4_done:
    s_waitcnt lgkmcnt(0)
    v_exp_f32 v36, v36
    v_exp_f32 v37, v37
    v_smfmac_f32_32x32x32_bf16 v[0:15], v[104:107], v[28:35], v116
    s_mov_b64 exec, s[50:51]
    ds_read_b128 v[100:103], v120 offset:20480
    ds_read_b128 v[104:107], v120 offset:20992
    s_mov_b64 exec, -1
    v_exp_f32 v38, v38
    v_exp_f32 v39, v39
    v_exp_f32 v40, v40
    v_mfma_f32_32x32x16_bf16 v[20:35], v[52:55], v[16:19], 0
    ds_read_b128 v[56:59], v118 offset:22528
    v_exp_f32 v41, v41
    v_exp_f32 v42, v42
    v_exp_f32 v43, v43
    v_exp_f32 v44, v44
    v_exp_f32 v45, v45
    v_smfmac_f32_32x32x32_bf16 v[0:15], v[108:111], v[36:43], v116
    v_exp_f32 v46, v46
    v_exp_f32 v47, v47
    v_exp_f32 v48, v48
    v_exp_f32 v49, v49
    v_exp_f32 v50, v50
    v_exp_f32 v51, v51
    s_waitcnt lgkmcnt(0)
    v_exp_f32 v20, v20
    v_exp_f32 v21, v21
    v_smfmac_f32_32x32x32_bf16 v[0:15], v[112:115], v[44:51], v116
    s_mov_b64 exec, s[50:51]
    ds_read_b128 v[108:111], v120 offset:22528
    ds_read_b128 v[112:115], v120 offset:23040
    s_mov_b64 exec, -1
    v_exp_f32 v22, v22
    v_exp_f32 v23, v23
    v_exp_f32 v24, v24
    v_mfma_f32_32x32x16_bf16 v[36:51], v[56:59], v[16:19], 0
    ds_read_b128 v[52:55], v118 offset:32768
    v_exp_f32 v25, v25
    v_exp_f32 v26, v26
    v_exp_f32 v27, v27
    v_exp_f32 v28, v28
    v_exp_f32 v29, v29
    v_smfmac_f32_32x32x32_bf16 v[0:15], v[100:103], v[20:27], v116
    v_exp_f32 v30, v30
    v_exp_f32 v31, v31
    v_exp_f32 v32, v32
    v_exp_f32 v33, v33
    v_exp_f32 v34, v34
    v_exp_f32 v35, v35
    s_waitcnt lgkmcnt(0)
    v_exp_f32 v36, v36
    v_exp_f32 v37, v37
    v_smfmac_f32_32x32x32_bf16 v[0:15], v[104:107], v[28:35], v116
    s_mov_b64 exec, s[50:51]
    ds_read_b128 v[100:103], v120 offset:32768
    ds_read_b128 v[104:107], v120 offset:33280
    s_mov_b64 exec, -1
    v_exp_f32 v38, v38
    v_exp_f32 v39, v39
    v_exp_f32 v40, v40
    v_mfma_f32_32x32x16_bf16 v[20:35], v[52:55], v[16:19], 0
    ds_read_b128 v[56:59], v118 offset:34816
    v_exp_f32 v41, v41
    v_exp_f32 v42, v42
    v_exp_f32 v43, v43
    v_exp_f32 v44, v44
    v_exp_f32 v45, v45
    v_smfmac_f32_32x32x32_bf16 v[0:15], v[108:111], v[36:43], v116
    v_exp_f32 v46, v46
    v_exp_f32 v47, v47
    v_exp_f32 v48, v48
    v_exp_f32 v49, v49
    v_exp_f32 v50, v50
    v_exp_f32 v51, v51
    s_waitcnt lgkmcnt(0)
    v_exp_f32 v20, v20
    v_exp_f32 v21, v21
    v_smfmac_f32_32x32x32_bf16 v[0:15], v[112:115], v[44:51], v116
    s_mov_b64 exec, s[50:51]
    ds_read_b128 v[108:111], v120 offset:34816
    ds_read_b128 v[112:115], v120 offset:35328
    s_mov_b64 exec, -1
    v_exp_f32 v22, v22
    v_exp_f32 v23, v23
    v_exp_f32 v24, v24
    v_mfma_f32_32x32x16_bf16 v[36:51], v[56:59], v[16:19], 0
    ds_read_b128 v[52:55], v118 offset:36864
    v_exp_f32 v25, v25
    v_exp_f32 v26, v26
    v_exp_f32 v27, v27
    v_exp_f32 v28, v28
    v_exp_f32 v29, v29
    v_smfmac_f32_32x32x32_bf16 v[0:15], v[100:103], v[20:27], v116
    v_exp_f32 v30, v30
    v_exp_f32 v31, v31
    v_exp_f32 v32, v32
    v_exp_f32 v33, v33
    v_exp_f32 v34, v34
    v_exp_f32 v35, v35
    s_waitcnt lgkmcnt(0)
    v_exp_f32 v36, v36
    v_exp_f32 v37, v37
    v_smfmac_f32_32x32x32_bf16 v[0:15], v[104:107], v[28:35], v116
    s_mov_b64 exec, s[50:51]
    ds_read_b128 v[100:103], v120 offset:36864
    ds_read_b128 v[104:107], v120 offset:37376
    s_mov_b64 exec, -1
    v_exp_f32 v38, v38
    v_exp_f32 v39, v39
    v_exp_f32 v40, v40
    v_mfma_f32_32x32x16_bf16 v[20:35], v[52:55], v[16:19], 0
    ds_read_b128 v[56:59], v118 offset:38912
    v_exp_f32 v41, v41
    v_exp_f32 v42, v42
    v_exp_f32 v43, v43
    v_exp_f32 v44, v44
    v_exp_f32 v45, v45
    v_smfmac_f32_32x32x32_bf16 v[0:15], v[108:111], v[36:43], v116
    v_exp_f32 v46, v46
    v_exp_f32 v47, v47
    v_exp_f32 v48, v48
    v_exp_f32 v49, v49
    v_exp_f32 v50, v50
    v_exp_f32 v51, v51
    s_waitcnt lgkmcnt(0)
    v_exp_f32 v20, v20
    v_exp_f32 v21, v21
    v_smfmac_f32_32x32x32_bf16 v[0:15], v[112:115], v[44:51], v116
    s_mov_b64 exec, s[50:51]
    ds_read_b128 v[108:111], v120 offset:38912
    ds_read_b128 v[112:115], v120 offset:39424
    s_mov_b64 exec, -1
    v_exp_f32 v22, v22
    v_exp_f32 v23, v23
    v_exp_f32 v24, v24
    v_mfma_f32_32x32x16_bf16 v[36:51], v[56:59], v[16:19], 0
    ds_read_b128 v[52:55], v118 offset:49152
    v_exp_f32 v25, v25
    v_exp_f32 v26, v26
    v_exp_f32 v27, v27
    v_exp_f32 v28, v28
    v_exp_f32 v29, v29
    v_smfmac_f32_32x32x32_bf16 v[0:15], v[100:103], v[20:27], v116
    v_exp_f32 v30, v30
    v_exp_f32 v31, v31
    v_exp_f32 v32, v32
    v_exp_f32 v33, v33
    v_exp_f32 v34, v34
    v_exp_f32 v35, v35
    s_setprio 2
    s_waitcnt lgkmcnt(0)
    v_exp_f32 v36, v36
    v_exp_f32 v37, v37
    v_smfmac_f32_32x32x32_bf16 v[0:15], v[104:107], v[28:35], v116
    s_mov_b64 exec, s[50:51]
    ds_read_b128 v[100:103], v120 offset:49152
    ds_read_b128 v[104:107], v120 offset:49664
    s_mov_b64 exec, -1
    v_exp_f32 v38, v38
    v_exp_f32 v39, v39
    v_exp_f32 v40, v40
    v_mfma_f32_32x32x16_bf16 v[20:35], v[52:55], v[16:19], 0
    ds_read_b128 v[56:59], v118 offset:51200
    v_exp_f32 v41, v41
    v_exp_f32 v42, v42
    v_exp_f32 v43, v43
    v_exp_f32 v44, v44
    v_exp_f32 v45, v45
    v_smfmac_f32_32x32x32_bf16 v[0:15], v[108:111], v[36:43], v116
    v_exp_f32 v46, v46
    v_exp_f32 v47, v47
    v_exp_f32 v48, v48
    v_exp_f32 v49, v49
    v_exp_f32 v50, v50
    v_exp_f32 v51, v51
    s_waitcnt lgkmcnt(0)
    v_exp_f32 v20, v20
    v_exp_f32 v21, v21
    v_smfmac_f32_32x32x32_bf16 v[0:15], v[112:115], v[44:51], v116
    s_mov_b64 exec, s[50:51]
    ds_read_b128 v[108:111], v120 offset:51200
    ds_read_b128 v[112:115], v120 offset:51712
    s_mov_b64 exec, -1
    v_exp_f32 v22, v22
    v_exp_f32 v23, v23
    v_exp_f32 v24, v24
    v_mfma_f32_32x32x16_bf16 v[36:51], v[56:59], v[16:19], 0
    ds_read_b128 v[52:55], v118 offset:53248
    v_exp_f32 v25, v25
    v_exp_f32 v26, v26
    v_exp_f32 v27, v27
    v_exp_f32 v28, v28
    v_exp_f32 v29, v29
    v_smfmac_f32_32x32x32_bf16 v[0:15], v[100:103], v[20:27], v116
    v_exp_f32 v30, v30
    v_exp_f32 v31, v31
    v_exp_f32 v32, v32
    v_exp_f32 v33, v33
    v_exp_f32 v34, v34
    v_exp_f32 v35, v35
    s_waitcnt lgkmcnt(0)
    v_exp_f32 v36, v36
    v_exp_f32 v37, v37
    v_smfmac_f32_32x32x32_bf16 v[0:15], v[104:107], v[28:35], v116
    s_mov_b64 exec, s[50:51]
    ds_read_b128 v[100:103], v120 offset:53248
    ds_read_b128 v[104:107], v120 offset:53760
    s_mov_b64 exec, -1
    v_exp_f32 v38, v38
    v_exp_f32 v39, v39
    v_exp_f32 v40, v40
    v_mfma_f32_32x32x16_bf16 v[20:35], v[52:55], v[16:19], 0
    ds_read_b128 v[56:59], v118 offset:55296
    v_exp_f32 v41, v41
    v_exp_f32 v42, v42
    v_exp_f32 v43, v43
    v_exp_f32 v44, v44
    v_exp_f32 v45, v45
    v_smfmac_f32_32x32x32_bf16 v[0:15], v[108:111], v[36:43], v116
    v_exp_f32 v46, v46
    v_exp_f32 v47, v47
    v_exp_f32 v48, v48
    v_exp_f32 v49, v49
    v_exp_f32 v50, v50
    v_exp_f32 v51, v51
    s_waitcnt lgkmcnt(0)
    v_exp_f32 v20, v20
    v_exp_f32 v21, v21
    v_smfmac_f32_32x32x32_bf16 v[0:15], v[112:115], v[44:51], v116
    s_mov_b64 exec, s[50:51]
    ds_read_b128 v[108:111], v120 offset:55296
    ds_read_b128 v[112:115], v120 offset:55808
    s_mov_b64 exec, -1
    v_exp_f32 v22, v22
    v_exp_f32 v23, v23
    v_exp_f32 v24, v24
    v_mfma_f32_32x32x16_bf16 v[36:51], v[56:59], v[16:19], 0
    ds_read_b128 v[52:55], v98 offset:0
    v_exp_f32 v25, v25
    v_exp_f32 v26, v26
    v_exp_f32 v27, v27
    v_exp_f32 v28, v28
    v_exp_f32 v29, v29
    v_smfmac_f32_32x32x32_bf16 v[0:15], v[100:103], v[20:27], v116
    v_exp_f32 v30, v30
    v_exp_f32 v31, v31
    v_exp_f32 v32, v32
    v_exp_f32 v33, v33
    v_exp_f32 v34, v34
    v_exp_f32 v35, v35
    s_waitcnt lgkmcnt(0)
    v_exp_f32 v36, v36
    v_exp_f32 v37, v37
    v_smfmac_f32_32x32x32_bf16 v[0:15], v[104:107], v[28:35], v116
    s_mov_b64 exec, s[50:51]
    ds_read_b128 v[100:103], v99 offset:0
    ds_read_b128 v[104:107], v99 offset:512
    s_mov_b64 exec, -1
    v_exp_f32 v38, v38
    v_exp_f32 v39, v39
    v_exp_f32 v40, v40
    v_mfma_f32_32x32x16_bf16 v[20:35], v[52:55], v[16:19], 0
    ds_read_b128 v[56:59], v98 offset:2048
    v_exp_f32 v41, v41
    v_exp_f32 v42, v42
    v_exp_f32 v43, v43
    v_exp_f32 v44, v44
    v_exp_f32 v45, v45
    v_smfmac_f32_32x32x32_bf16 v[0:15], v[108:111], v[36:43], v116
    v_exp_f32 v46, v46
    v_exp_f32 v47, v47
    v_exp_f32 v48, v48
    v_exp_f32 v49, v49
    v_exp_f32 v50, v50
    v_exp_f32 v51, v51
    s_setprio 1
    s_waitcnt lgkmcnt(0)
    v_exp_f32 v20, v20
    v_exp_f32 v21, v21
    v_smfmac_f32_32x32x32_bf16 v[0:15], v[112:115], v[44:51], v116
    s_mov_b64 exec, s[50:51]
    ds_read_b128 v[108:111], v99 offset:2048
    ds_read_b128 v[112:115], v99 offset:2560
    s_mov_b64 exec, -1
    v_exp_f32 v22, v22
    v_exp_f32 v23, v23
    v_exp_f32 v24, v24
    v_mfma_f32_32x32x16_bf16 v[36:51], v[56:59], v[16:19], 0
    ds_read_b128 v[52:55], v98 offset:4096
    v_exp_f32 v25, v25
    v_exp_f32 v26, v26
    v_exp_f32 v27, v27
    v_exp_f32 v28, v28
    v_exp_f32 v29, v29
    v_smfmac_f32_32x32x32_bf16 v[0:15], v[100:103], v[20:27], v116
    v_exp_f32 v30, v30
    v_exp_f32 v31, v31
    v_exp_f32 v32, v32
    v_exp_f32 v33, v33
    v_exp_f32 v34, v34
    v_exp_f32 v35, v35
    s_waitcnt lgkmcnt(0)
    v_exp_f32 v36, v36
    v_exp_f32 v37, v37
    v_smfmac_f32_32x32x32_bf16 v[0:15], v[104:107], v[28:35], v116
    s_mov_b64 exec, s[50:51]
    ds_read_b128 v[100:103], v99 offset:4096
    ds_read_b128 v[104:107], v99 offset:4608
    s_mov_b64 exec, -1
    v_exp_f32 v38, v38
    v_exp_f32 v39, v39
    v_exp_f32 v40, v40
    v_mfma_f32_32x32x16_bf16 v[20:35], v[52:55], v[16:19], 0
    ds_read_b128 v[56:59], v98 offset:6144
    v_exp_f32 v41, v41
    v_exp_f32 v42, v42
    v_exp_f32 v43, v43
    v_exp_f32 v44, v44
    v_exp_f32 v45, v45
    v_smfmac_f32_32x32x32_bf16 v[0:15], v[108:111], v[36:43], v116
    v_exp_f32 v46, v46
    v_exp_f32 v47, v47
    v_exp_f32 v48, v48
    v_exp_f32 v49, v49
    v_exp_f32 v50, v50
    v_exp_f32 v51, v51
    s_setprio 0
    s_waitcnt lgkmcnt(0)
    v_exp_f32 v20, v20
    v_exp_f32 v21, v21
    v_smfmac_f32_32x32x32_bf16 v[0:15], v[112:115], v[44:51], v116
    s_mov_b64 exec, s[50:51]
    ds_read_b128 v[108:111], v99 offset:6144
    ds_read_b128 v[112:115], v99 offset:6656
    s_mov_b64 exec, -1
    v_exp_f32 v22, v22
    v_exp_f32 v23, v23
    v_exp_f32 v24, v24
    v_mfma_f32_32x32x16_bf16 v[36:51], v[56:59], v[16:19], 0
    s_waitcnt vmcnt(0)
    s_barrier
    s_setprio 3
    ds_read_b128 v[52:55], v98 offset:16384
    v_exp_f32 v25, v25
    v_exp_f32 v26, v26
    v_exp_f32 v27, v27
    v_exp_f32 v28, v28
    v_exp_f32 v29, v29
    v_smfmac_f32_32x32x32_bf16 v[0:15], v[100:103], v[20:27], v116
    v_exp_f32 v30, v30
    v_exp_f32 v31, v31
    v_exp_f32 v32, v32
    v_exp_f32 v33, v33
    v_exp_f32 v34, v34
    v_exp_f32 v35, v35
    s_waitcnt lgkmcnt(0)
    v_exp_f32 v36, v36
    v_exp_f32 v37, v37
    v_smfmac_f32_32x32x32_bf16 v[0:15], v[104:107], v[28:35], v116
    s_mov_b64 exec, s[50:51]
    ds_read_b128 v[100:103], v99 offset:16384
    ds_read_b128 v[104:107], v99 offset:16896
    s_mov_b64 exec, -1
    v_exp_f32 v38, v38
    v_exp_f32 v39, v39
    v_exp_f32 v40, v40
    v_mfma_f32_32x32x16_bf16 v[20:35], v[52:55], v[16:19], 0
    ds_read_b128 v[56:59], v98 offset:18432
    v_exp_f32 v41, v41
    v_exp_f32 v42, v42
    v_exp_f32 v43, v43
    v_exp_f32 v44, v44
    v_exp_f32 v45, v45
    v_smfmac_f32_32x32x32_bf16 v[0:15], v[108:111], v[36:43], v116
    v_exp_f32 v46, v46
    v_exp_f32 v47, v47
    v_exp_f32 v48, v48
    v_exp_f32 v49, v49
    v_exp_f32 v50, v50
    v_exp_f32 v51, v51
    s_sub_u32 s52, s25, 8
    s_cmp_ge_u32 s52, 8
    s_cbranch_scc1 L_f5_p
    s_lshr_b32 s63, s52, 2
    s_lshl_b32 s63, s63, 2
    s_lshr_b32 s53, 0xfd, s63
    s_and_b32 s53, s53, 15
    s_lshl_b32 s57, s24, 1
    s_xor_b32 s53, s53, s57
    s_lshl_b32 s57, s53, 7
    s_add_u32 s57, s57, s60
    s_mov_b64 exec, 15
    buffer_load_dwordx2 v[122:123], v126, s[36:39], s57 offen sc1
    s_mov_b64 exec, -1
    s_lshl_b32 s53, s53, 14
    s_add_u32 s56, s53, s54
    s_and_b32 s52, s52, 3
    s_mul_i32 s52, s52, 4096
    s_add_u32 s56, s56, s52
    s_lshr_b32 s53, 0x54, s63
    s_and_b32 s53, s53, 15
    s_lshl_b32 s53, s53, 14
    s_add_u32 s52, s52, s53
L_f5_p:
    s_waitcnt lgkmcnt(0)
    v_exp_f32 v20, v20
    v_exp_f32 v21, v21
    v_smfmac_f32_32x32x32_bf16 v[0:15], v[112:115], v[44:51], v116
    s_mov_b64 exec, s[50:51]
    ds_read_b128 v[108:111], v99 offset:18432
    ds_read_b128 v[112:115], v99 offset:18944
    s_mov_b64 exec, -1
    v_exp_f32 v22, v22
    v_exp_f32 v23, v23
    v_exp_f32 v24, v24
    v_mfma_f32_32x32x16_bf16 v[36:51], v[56:59], v[16:19], 0
    ds_read_b128 v[52:55], v98 offset:20480
    v_exp_f32 v25, v25
    v_exp_f32 v26, v26
    v_exp_f32 v27, v27
    v_exp_f32 v28, v28
    v_exp_f32 v29, v29
    v_smfmac_f32_32x32x32_bf16 v[0:15], v[100:103], v[20:27], v116
    v_exp_f32 v30, v30
    v_exp_f32 v31, v31
    v_exp_f32 v32, v32
    v_exp_f32 v33, v33
    v_exp_f32 v34, v34
    v_exp_f32 v35, v35
    s_sub_u32 s53, s25, 8
    s_cmp_ge_u32 s53, 8
    s_cbranch_scc1 L_f5_done
    s_mov_b64 exec, 15
    s_mov_b32 s63, 262144
L_f5_chk:
    s_waitcnt vmcnt(0)
    v_cmp_eq_u64 vcc, s[48:49], v[122:123]
    s_nop 1
    s_cmp_eq_u64 vcc, 15
    s_cbranch_scc1 L_f5_ok
    s_sleep 4
    buffer_load_dwordx2 v[122:123], v126, s[36:39], s57 offen sc1
    s_sub_u32 s63, s63, 1
    s_cmp_lg_u32 s63, 0
    s_cbranch_scc1 L_f5_chk
    s_waitcnt vmcnt(0)
L_f5_ok:
    s_mov_b64 exec, -1
    s_add_u32 m0, s52, 0
    s_add_u32 s53, s56, 0
    buffer_load_dwordx4 v121, s[36:39], s53 offen offset:0 sc1 lds
    buffer_load_dwordx4 v121, s[36:39], s53 offen offset:1024 sc1 lds
    buffer_load_dwordx4 v121, s[36:39], s53 offen offset:2048 sc1 lds
    buffer_load_dwordx4 v121, s[36:39], s53 offen offset:3072 sc1 lds
L_f5_done:
    s_waitcnt lgkmcnt(0)
    v_exp_f32 v36, v36
    v_exp_f32 v37, v37
    v_smfmac_f32_32x32x32_bf16 v[0:15], v[104:107], v[28:35], v116
    s_mov_b64 exec, s[50:51]
    ds_read_b128 v[100:103], v99 offset:20480
    ds_read_b128 v[104:107], v99 offset:20992
    s_mov_b64 exec, -1
    v_exp_f32 v38, v38
    v_exp_f32 v39, v39
    v_exp_f32 v40, v40
    v_mfma_f32_32x32x16_bf16 v[20:35], v[52:55], v[16:19], 0
    ds_read_b128 v[56:59], v98 offset:22528
    v_exp_f32 v41, v41
    v_exp_f32 v42, v42
    v_exp_f32 v43, v43
    v_exp_f32 v44, v44
    v_exp_f32 v45, v45
    v_smfmac_f32_32x32x32_bf16 v[0:15], v[108:111], v[36:43], v116
    v_exp_f32 v46, v46
    v_exp_f32 v47, v47
    v_exp_f32 v48, v48
    v_exp_f32 v49, v49
    v_exp_f32 v50, v50
    v_exp_f32 v51, v51
    s_lshl_b32 s63, s25, 13
    s_add_u32 m0, s62, 98304
    s_add_u32 s53, s63, 0
    buffer_load_dwordx4 v61, s[40:43], s53 offen lds
    s_waitcnt lgkmcnt(0)
    v_exp_f32 v20, v20
    v_exp_f32 v21, v21
    v_smfmac_f32_32x32x32_bf16 v[0:15], v[112:115], v[44:51], v116
    s_mov_b64 exec, s[50:51]
    ds_read_b128 v[108:111], v99 offset:22528
    ds_read_b128 v[112:115], v99 offset:23040
    s_mov_b64 exec, -1
    v_exp_f32 v22, v22
    v_exp_f32 v23, v23
    v_exp_f32 v24, v24
    v_mfma_f32_32x32x16_bf16 v[36:51], v[56:59], v[16:19], 0
    ds_read_b128 v[52:55], v117 offset:0
    v_exp_f32 v25, v25
    v_exp_f32 v26, v26
    v_exp_f32 v27, v27
    v_exp_f32 v28, v28
    v_exp_f32 v29, v29
    v_smfmac_f32_32x32x32_bf16 v[0:15], v[100:103], v[20:27], v116
    v_exp_f32 v30, v30
    v_exp_f32 v31, v31
    v_exp_f32 v32, v32
    v_exp_f32 v33, v33
    v_exp_f32 v34, v34
    v_exp_f32 v35, v35
    s_lshl_b32 s63, s25, 13
    s_add_u32 m0, s62, 114688
    s_add_u32 s53, s63, 131072
    buffer_load_dwordx4 v61, s[40:43], s53 offen lds
    s_waitcnt lgkmcnt(0)
    v_exp_f32 v36, v36
    v_exp_f32 v37, v37
    v_smfmac_f32_32x32x32_bf16 v[0:15], v[104:107], v[28:35], v116
    s_mov_b64 exec, s[50:51]
    ds_read_b128 v[100:103], v119 offset:0
    ds_read_b128 v[104:107], v119 offset:512
    s_mov_b64 exec, -1
    v_exp_f32 v38, v38
    v_exp_f32 v39, v39
    v_exp_f32 v40, v40
    v_mfma_f32_32x32x16_bf16 v[20:35], v[52:55], v[16:19], 0
    ds_read_b128 v[56:59], v117 offset:2048
    v_exp_f32 v41, v41
    v_exp_f32 v42, v42
    v_exp_f32 v43, v43
    v_exp_f32 v44, v44
    v_exp_f32 v45, v45
    v_smfmac_f32_32x32x32_bf16 v[0:15], v[108:111], v[36:43], v116
    v_exp_f32 v46, v46
    v_exp_f32 v47, v47
    v_exp_f32 v48, v48
    v_exp_f32 v49, v49
    v_exp_f32 v50, v50
    v_exp_f32 v51, v51
    s_waitcnt lgkmcnt(0)
    v_exp_f32 v20, v20
    v_exp_f32 v21, v21
    v_smfmac_f32_32x32x32_bf16 v[0:15], v[112:115], v[44:51], v116
    s_mov_b64 exec, s[50:51]
    ds_read_b128 v[108:111], v119 offset:2048
    ds_read_b128 v[112:115], v119 offset:2560
    s_mov_b64 exec, -1
    v_exp_f32 v22, v22
    v_exp_f32 v23, v23
    v_exp_f32 v24, v24
    v_mfma_f32_32x32x16_bf16 v[36:51], v[56:59], v[16:19], 0
    ds_read_b128 v[52:55], v117 offset:4096
    v_exp_f32 v25, v25
    v_exp_f32 v26, v26
    v_exp_f32 v27, v27
    v_exp_f32 v28, v28
    v_exp_f32 v29, v29
    v_smfmac_f32_32x32x32_bf16 v[0:15], v[100:103], v[20:27], v116
    v_exp_f32 v30, v30
    v_exp_f32 v31, v31
    v_exp_f32 v32, v32
    v_exp_f32 v33, v33
    v_exp_f32 v34, v34
    v_exp_f32 v35, v35
    s_waitcnt lgkmcnt(0)
    v_exp_f32 v36, v36
    v_exp_f32 v37, v37
    v_smfmac_f32_32x32x32_bf16 v[0:15], v[104:107], v[28:35], v116
    s_mov_b64 exec, s[50:51]
    ds_read_b128 v[100:103], v119 offset:4096
    ds_read_b128 v[104:107], v119 offset:4608
    s_mov_b64 exec, -1
    v_exp_f32 v38, v38
    v_exp_f32 v39, v39
    v_exp_f32 v40, v40
    v_mfma_f32_32x32x16_bf16 v[20:35], v[52:55], v[16:19], 0
    ds_read_b128 v[56:59], v117 offset:6144
    v_exp_f32 v41, v41
    v_exp_f32 v42, v42
    v_exp_f32 v43, v43
    v_exp_f32 v44, v44
    v_exp_f32 v45, v45
    v_smfmac_f32_32x32x32_bf16 v[0:15], v[108:111], v[36:43], v116
    v_exp_f32 v46, v46
    v_exp_f32 v47, v47
    v_exp_f32 v48, v48
    v_exp_f32 v49, v49
    v_exp_f32 v50, v50
    v_exp_f32 v51, v51
    s_waitcnt lgkmcnt(0)
    v_exp_f32 v20, v20
    v_exp_f32 v21, v21
    v_smfmac_f32_32x32x32_bf16 v[0:15], v[112:115], v[44:51], v116
    s_mov_b64 exec, s[50:51]
    ds_read_b128 v[108:111], v119 offset:6144
    ds_read_b128 v[112:115], v119 offset:6656
    s_mov_b64 exec, -1
    v_exp_f32 v22, v22
    v_exp_f32 v23, v23
    v_exp_f32 v24, v24
    v_mfma_f32_32x32x16_bf16 v[36:51], v[56:59], v[16:19], 0
    ds_read_b128 v[52:55], v117 offset:16384
    v_exp_f32 v25, v25
    v_exp_f32 v26, v26
    v_exp_f32 v27, v27
    v_exp_f32 v28, v28
    v_exp_f32 v29, v29
    v_smfmac_f32_32x32x32_bf16 v[0:15], v[100:103], v[20:27], v116
    v_exp_f32 v30, v30
    v_exp_f32 v31, v31
    v_exp_f32 v32, v32
    v_exp_f32 v33, v33
    v_exp_f32 v34, v34
    v_exp_f32 v35, v35
    s_waitcnt lgkmcnt(0)
    v_exp_f32 v36, v36
    v_exp_f32 v37, v37
    v_smfmac_f32_32x32x32_bf16 v[0:15], v[104:107], v[28:35], v116
    s_mov_b64 exec, s[50:51]
    ds_read_b128 v[100:103], v119 offset:16384
    ds_read_b128 v[104:107], v119 offset:16896
    s_mov_b64 exec, -1
    v_exp_f32 v38, v38
    v_exp_f32 v39, v39
    v_exp_f32 v40, v40
    v_mfma_f32_32x32x16_bf16 v[20:35], v[52:55], v[16:19], 0
    ds_read_b128 v[56:59], v117 offset:18432
    v_exp_f32 v41, v41
    v_exp_f32 v42, v42
    v_exp_f32 v43, v43
    v_exp_f32 v44, v44
    v_exp_f32 v45, v45
    v_smfmac_f32_32x32x32_bf16 v[0:15], v[108:111], v[36:43], v116
    v_exp_f32 v46, v46
    v_exp_f32 v47, v47
    v_exp_f32 v48, v48
    v_exp_f32 v49, v49
    v_exp_f32 v50, v50
    v_exp_f32 v51, v51
    s_waitcnt lgkmcnt(0)
    v_exp_f32 v20, v20
    v_exp_f32 v21, v21
    v_smfmac_f32_32x32x32_bf16 v[0:15], v[112:115], v[44:51], v116
    s_mov_b64 exec, s[50:51]
    ds_read_b128 v[108:111], v119 offset:18432
    ds_read_b128 v[112:115], v119 offset:18944
    s_mov_b64 exec, -1
    v_exp_f32 v22, v22
    v_exp_f32 v23, v23
    v_exp_f32 v24, v24
    v_mfma_f32_32x32x16_bf16 v[36:51], v[56:59], v[16:19], 0
    ds_read_b128 v[52:55], v117 offset:20480
    v_exp_f32 v25, v25
    v_exp_f32 v26, v26
    v_exp_f32 v27, v27
    v_exp_f32 v28, v28
    v_exp_f32 v29, v29
    v_smfmac_f32_32x32x32_bf16 v[0:15], v[100:103], v[20:27], v116
    v_exp_f32 v30, v30
    v_exp_f32 v31, v31
    v_exp_f32 v32, v32
    v_exp_f32 v33, v33
    v_exp_f32 v34, v34
    v_exp_f32 v35, v35
    s_setprio 2
    s_waitcnt lgkmcnt(0)
    v_exp_f32 v36, v36
    v_exp_f32 v37, v37
    v_smfmac_f32_32x32x32_bf16 v[0:15], v[104:107], v[28:35], v116
    s_mov_b64 exec, s[50:51]
    ds_read_b128 v[100:103], v119 offset:20480
    ds_read_b128 v[104:107], v119 offset:20992
    s_mov_b64 exec, -1
    v_exp_f32 v38, v38
    v_exp_f32 v39, v39
    v_exp_f32 v40, v40
    v_mfma_f32_32x32x16_bf16 v[20:35], v[52:55], v[16:19], 0
    ds_read_b128 v[56:59], v117 offset:22528
    v_exp_f32 v41, v41
    v_exp_f32 v42, v42
    v_exp_f32 v43, v43
    v_exp_f32 v44, v44
    v_exp_f32 v45, v45
    v_smfmac_f32_32x32x32_bf16 v[0:15], v[108:111], v[36:43], v116
    v_exp_f32 v46, v46
    v_exp_f32 v47, v47
    v_exp_f32 v48, v48
    v_exp_f32 v49, v49
    v_exp_f32 v50, v50
    v_exp_f32 v51, v51
    s_waitcnt lgkmcnt(0)
    v_exp_f32 v20, v20
    v_exp_f32 v21, v21
    v_smfmac_f32_32x32x32_bf16 v[0:15], v[112:115], v[44:51], v116
    s_mov_b64 exec, s[50:51]
    ds_read_b128 v[108:111], v119 offset:22528
    ds_read_b128 v[112:115], v119 offset:23040
    s_mov_b64 exec, -1
    v_exp_f32 v22, v22
    v_exp_f32 v23, v23
    v_exp_f32 v24, v24
    v_mfma_f32_32x32x16_bf16 v[36:51], v[56:59], v[16:19], 0
    ds_read_b128 v[52:55], v117 offset:32768
    v_exp_f32 v25, v25
    v_exp_f32 v26, v26
    v_exp_f32 v27, v27
    v_exp_f32 v28, v28
    v_exp_f32 v29, v29
    v_smfmac_f32_32x32x32_bf16 v[0:15], v[100:103], v[20:27], v116
    v_exp_f32 v30, v30
    v_exp_f32 v31, v31
    v_exp_f32 v32, v32
    v_exp_f32 v33, v33
    v_exp_f32 v34, v34
    v_exp_f32 v35, v35
    buffer_load_dwordx2 v[124:125], v127, s[36:39], s10 offen sc1
    buffer_load_dword v123, v60, s[36:39], s59 offen
    buffer_load_dword v122, v121, s[36:39], s58 offen
    s_waitcnt lgkmcnt(0)
    v_exp_f32 v36, v36
    v_exp_f32 v37, v37
    v_smfmac_f32_32x32x32_bf16 v[0:15], v[104:107], v[28:35], v116
    s_mov_b64 exec, s[50:51]
    ds_read_b128 v[100:103], v119 offset:32768
    ds_read_b128 v[104:107], v119 offset:33280
    s_mov_b64 exec, -1
    v_exp_f32 v38, v38
    v_exp_f32 v39, v39
    v_exp_f32 v40, v40
    v_mfma_f32_32x32x16_bf16 v[20:35], v[52:55], v[16:19], 0
    ds_read_b128 v[56:59], v117 offset:34816
    v_exp_f32 v41, v41
    v_exp_f32 v42, v42
    v_exp_f32 v43, v43
    v_exp_f32 v44, v44
    v_exp_f32 v45, v45
    v_smfmac_f32_32x32x32_bf16 v[0:15], v[108:111], v[36:43], v116
    v_exp_f32 v46, v46
    v_exp_f32 v47, v47
    v_exp_f32 v48, v48
    v_exp_f32 v49, v49
    v_exp_f32 v50, v50
    v_exp_f32 v51, v51
    s_waitcnt lgkmcnt(0)
    v_exp_f32 v20, v20
    v_exp_f32 v21, v21
    v_smfmac_f32_32x32x32_bf16 v[0:15], v[112:115], v[44:51], v116
    s_mov_b64 exec, s[50:51]
    ds_read_b128 v[108:111], v119 offset:34816
    ds_read_b128 v[112:115], v119 offset:35328
    s_mov_b64 exec, -1
    v_exp_f32 v22, v22
    v_exp_f32 v23, v23
    v_exp_f32 v24, v24
    v_mfma_f32_32x32x16_bf16 v[36:51], v[56:59], v[16:19], 0
    ds_read_b128 v[52:55], v117 offset:36864
    v_exp_f32 v25, v25
    v_exp_f32 v26, v26
    v_exp_f32 v27, v27
    v_exp_f32 v28, v28
    v_exp_f32 v29, v29
    v_smfmac_f32_32x32x32_bf16 v[0:15], v[100:103], v[20:27], v116
    v_exp_f32 v30, v30
    v_exp_f32 v31, v31
    v_exp_f32 v32, v32
    v_exp_f32 v33, v33
    v_exp_f32 v34, v34
    v_exp_f32 v35, v35
    s_waitcnt lgkmcnt(0)
    v_exp_f32 v36, v36
    v_exp_f32 v37, v37
    v_smfmac_f32_32x32x32_bf16 v[0:15], v[104:107], v[28:35], v116
    s_mov_b64 exec, s[50:51]
    ds_read_b128 v[100:103], v119 offset:36864
    ds_read_b128 v[104:107], v119 offset:37376
    s_mov_b64 exec, -1
    v_exp_f32 v38, v38
    v_exp_f32 v39, v39
    v_exp_f32 v40, v40
    v_mfma_f32_32x32x16_bf16 v[20:35], v[52:55], v[16:19], 0
    ds_read_b128 v[56:59], v117 offset:38912
    v_exp_f32 v41, v41
    v_exp_f32 v42, v42
    v_exp_f32 v43, v43
    v_exp_f32 v44, v44
    v_exp_f32 v45, v45
    v_smfmac_f32_32x32x32_bf16 v[0:15], v[108:111], v[36:43], v116
    v_exp_f32 v46, v46
    v_exp_f32 v47, v47
    v_exp_f32 v48, v48
    v_exp_f32 v49, v49
    v_exp_f32 v50, v50
    v_exp_f32 v51, v51
    s_waitcnt lgkmcnt(0)
    v_exp_f32 v20, v20
    v_exp_f32 v21, v21
    v_smfmac_f32_32x32x32_bf16 v[0:15], v[112:115], v[44:51], v116
    s_mov_b64 exec, s[50:51]
    ds_read_b128 v[108:111], v119 offset:38912
    ds_read_b128 v[112:115], v119 offset:39424
    s_mov_b64 exec, -1
    v_exp_f32 v22, v22
    v_exp_f32 v23, v23
    v_exp_f32 v24, v24
    v_mfma_f32_32x32x16_bf16 v[36:51], v[56:59], v[16:19], 0
    ds_read_b128 v[52:55], v117 offset:49152
    v_exp_f32 v25, v25
    v_exp_f32 v26, v26
    v_exp_f32 v27, v27
    v_exp_f32 v28, v28
    v_exp_f32 v29, v29
    v_smfmac_f32_32x32x32_bf16 v[0:15], v[100:103], v[20:27], v116
    v_exp_f32 v30, v30
    v_exp_f32 v31, v31
    v_exp_f32 v32, v32
    v_exp_f32 v33, v33
    v_exp_f32 v34, v34
    v_exp_f32 v35, v35
    s_waitcnt lgkmcnt(0)
    v_exp_f32 v36, v36
    v_exp_f32 v37, v37
    v_smfmac_f32_32x32x32_bf16 v[0:15], v[104:107], v[28:35], v116
    s_mov_b64 exec, s[50:51]
    ds_read_b128 v[100:103], v119 offset:49152
    ds_read_b128 v[104:107], v119 offset:49664
    s_mov_b64 exec, -1
    v_exp_f32 v38, v38
    v_exp_f32 v39, v39
    v_exp_f32 v40, v40
    v_mfma_f32_32x32x16_bf16 v[20:35], v[52:55], v[16:19], 0
    ds_read_b128 v[56:59], v117 offset:51200
    v_exp_f32 v41, v41
    v_exp_f32 v42, v42
    v_exp_f32 v43, v43
    v_exp_f32 v44, v44
    v_exp_f32 v45, v45
    v_smfmac_f32_32x32x32_bf16 v[0:15], v[108:111], v[36:43], v116
    v_exp_f32 v46, v46
    v_exp_f32 v47, v47
    v_exp_f32 v48, v48
    v_exp_f32 v49, v49
    v_exp_f32 v50, v50
    v_exp_f32 v51, v51
    s_setprio 1
    s_waitcnt lgkmcnt(0)
    v_exp_f32 v20, v20
    v_exp_f32 v21, v21
    v_smfmac_f32_32x32x32_bf16 v[0:15], v[112:115], v[44:51], v116
    s_mov_b64 exec, s[50:51]
    ds_read_b128 v[108:111], v119 offset:51200
    ds_read_b128 v[112:115], v119 offset:51712
    s_mov_b64 exec, -1
    v_exp_f32 v22, v22
    v_exp_f32 v23, v23
    v_exp_f32 v24, v24
    v_mfma_f32_32x32x16_bf16 v[36:51], v[56:59], v[16:19], 0
    ds_read_b128 v[52:55], v117 offset:53248
    v_exp_f32 v25, v25
    v_exp_f32 v26, v26
    v_exp_f32 v27, v27
    v_exp_f32 v28, v28
    v_exp_f32 v29, v29
    v_smfmac_f32_32x32x32_bf16 v[0:15], v[100:103], v[20:27], v116
    v_exp_f32 v30, v30
    v_exp_f32 v31, v31
    v_exp_f32 v32, v32
    v_exp_f32 v33, v33
    v_exp_f32 v34, v34
    v_exp_f32 v35, v35
    s_waitcnt lgkmcnt(0)
    v_exp_f32 v36, v36
    v_exp_f32 v37, v37
    v_smfmac_f32_32x32x32_bf16 v[0:15], v[104:107], v[28:35], v116
    s_mov_b64 exec, s[50:51]
    ds_read_b128 v[100:103], v119 offset:53248
    ds_read_b128 v[104:107], v119 offset:53760
    s_mov_b64 exec, -1
    v_exp_f32 v38, v38
    v_exp_f32 v39, v39
    v_exp_f32 v40, v40
    v_mfma_f32_32x32x16_bf16 v[20:35], v[52:55], v[16:19], 0
    ds_read_b128 v[56:59], v117 offset:55296
    v_exp_f32 v41, v41
    v_exp_f32 v42, v42
    v_exp_f32 v43, v43
    v_exp_f32 v44, v44
    v_exp_f32 v45, v45
    v_smfmac_f32_32x32x32_bf16 v[0:15], v[108:111], v[36:43], v116
    v_exp_f32 v46, v46
    v_exp_f32 v47, v47
    v_exp_f32 v48, v48
    v_exp_f32 v49, v49
    v_exp_f32 v50, v50
    v_exp_f32 v51, v51
    s_setprio 0
    s_waitcnt lgkmcnt(0)
    v_exp_f32 v20, v20
    v_exp_f32 v21, v21
    v_smfmac_f32_32x32x32_bf16 v[0:15], v[112:115], v[44:51], v116
    s_mov_b64 exec, s[50:51]
    ds_read_b128 v[108:111], v119 offset:55296
    ds_read_b128 v[112:115], v119 offset:55808
    s_mov_b64 exec, -1
    v_exp_f32 v22, v22
    v_exp_f32 v23, v23
    v_exp_f32 v24, v24
    v_mfma_f32_32x32x16_bf16 v[36:51], v[56:59], v[16:19], 0
    s_waitcnt vmcnt(0)
    s_barrier
    s_setprio 3
    ds_read_b128 v[52:55], v118 offset:0
    v_exp_f32 v25, v25
    v_exp_f32 v26, v26
    v_exp_f32 v27, v27
    v_exp_f32 v28, v28
    v_exp_f32 v29, v29
    v_smfmac_f32_32x32x32_bf16 v[0:15], v[100:103], v[20:27], v116
    v_exp_f32 v30, v30
    v_exp_f32 v31, v31
    v_exp_f32 v32, v32
    v_exp_f32 v33, v33
    v_exp_f32 v34, v34
    v_exp_f32 v35, v35
    s_waitcnt lgkmcnt(0)
    v_exp_f32 v36, v36
    v_exp_f32 v37, v37
    v_smfmac_f32_32x32x32_bf16 v[0:15], v[104:107], v[28:35], v116
    s_mov_b64 exec, s[50:51]
    ds_read_b128 v[100:103], v120 offset:0
    ds_read_b128 v[104:107], v120 offset:512
    s_mov_b64 exec, -1
    v_exp_f32 v38, v38
    v_exp_f32 v39, v39
    v_exp_f32 v40, v40
    v_mfma_f32_32x32x16_bf16 v[20:35], v[52:55], v[16:19], 0
    ds_read_b128 v[56:59], v118 offset:2048
    v_exp_f32 v41, v41
    v_exp_f32 v42, v42
    v_exp_f32 v43, v43
    v_exp_f32 v44, v44
    v_exp_f32 v45, v45
    v_smfmac_f32_32x32x32_bf16 v[0:15], v[108:111], v[36:43], v116
    v_exp_f32 v46, v46
    v_exp_f32 v47, v47
    v_exp_f32 v48, v48
    v_exp_f32 v49, v49
    v_exp_f32 v50, v50
    v_exp_f32 v51, v51
    s_or_b32 s52, s48, s26
    s_mov_b32 s53, s49
    v_cmp_eq_u64 vcc, s[52:53], v[124:125]
    s_nop 1
    s_cmp_eq_u64 vcc, -1
    s_cselect_b32 s27, 1, 0
    s_waitcnt lgkmcnt(0)
    v_exp_f32 v20, v20
    v_exp_f32 v21, v21
    v_smfmac_f32_32x32x32_bf16 v[0:15], v[112:115], v[44:51], v116
    s_mov_b64 exec, s[50:51]
    ds_read_b128 v[108:111], v120 offset:2048
    ds_read_b128 v[112:115], v120 offset:2560
    s_mov_b64 exec, -1
    v_exp_f32 v22, v22
    v_exp_f32 v23, v23
    v_exp_f32 v24, v24
    v_mfma_f32_32x32x16_bf16 v[36:51], v[56:59], v[16:19], 0
    ds_read_b128 v[52:55], v118 offset:4096
    v_exp_f32 v25, v25
    v_exp_f32 v26, v26
    v_exp_f32 v27, v27
    v_exp_f32 v28, v28
    v_exp_f32 v29, v29
    v_smfmac_f32_32x32x32_bf16 v[0:15], v[100:103], v[20:27], v116
    v_exp_f32 v30, v30
    v_exp_f32 v31, v31
    v_exp_f32 v32, v32
    v_exp_f32 v33, v33
    v_exp_f32 v34, v34
    v_exp_f32 v35, v35
    s_lshl_b32 s63, s25, 13
    s_add_u32 m0, s62, 131072
    s_add_u32 s53, s63, 262144
    buffer_load_dwordx4 v61, s[40:43], s53 offen lds
    s_waitcnt lgkmcnt(0)
    v_exp_f32 v36, v36
    v_exp_f32 v37, v37
    v_smfmac_f32_32x32x32_bf16 v[0:15], v[104:107], v[28:35], v116
    s_mov_b64 exec, s[50:51]
    ds_read_b128 v[100:103], v120 offset:4096
    ds_read_b128 v[104:107], v120 offset:4608
    s_mov_b64 exec, -1
    v_exp_f32 v38, v38
    v_exp_f32 v39, v39
    v_exp_f32 v40, v40
    v_mfma_f32_32x32x16_bf16 v[20:35], v[52:55], v[16:19], 0
    ds_read_b128 v[56:59], v118 offset:6144
    v_exp_f32 v41, v41
    v_exp_f32 v42, v42
    v_exp_f32 v43, v43
    v_exp_f32 v44, v44
    v_exp_f32 v45, v45
    v_smfmac_f32_32x32x32_bf16 v[0:15], v[108:111], v[36:43], v116
    v_exp_f32 v46, v46
    v_exp_f32 v47, v47
    v_exp_f32 v48, v48
    v_exp_f32 v49, v49
    v_exp_f32 v50, v50
    v_exp_f32 v51, v51
    s_lshl_b32 s63, s25, 13
    s_add_u32 m0, s62, 147456
    s_add_u32 s53, s63, 393216
    buffer_load_dwordx4 v61, s[40:43], s53 offen lds
    s_waitcnt lgkmcnt(0)
    v_exp_f32 v20, v20
    v_exp_f32 v21, v21
    v_smfmac_f32_32x32x32_bf16 v[0:15], v[112:115], v[44:51], v116
    s_mov_b64 exec, s[50:51]
    ds_read_b128 v[108:111], v120 offset:6144
    ds_read_b128 v[112:115], v120 offset:6656
    s_mov_b64 exec, -1
    v_exp_f32 v22, v22
    v_exp_f32 v23, v23
    v_exp_f32 v24, v24
    v_mfma_f32_32x32x16_bf16 v[36:51], v[56:59], v[16:19], 0
    ds_read_b128 v[52:55], v118 offset:16384
    v_exp_f32 v25, v25
    v_exp_f32 v26, v26
    v_exp_f32 v27, v27
    v_exp_f32 v28, v28
    v_exp_f32 v29, v29
    v_smfmac_f32_32x32x32_bf16 v[0:15], v[100:103], v[20:27], v116
    v_exp_f32 v30, v30
    v_exp_f32 v31, v31
    v_exp_f32 v32, v32
    v_exp_f32 v33, v33
    v_exp_f32 v34, v34
    v_exp_f32 v35, v35
    s_waitcnt lgkmcnt(0)
    v_exp_f32 v36, v36
    v_exp_f32 v37, v37
    v_smfmac_f32_32x32x32_bf16 v[0:15], v[104:107], v[28:35], v116
    s_mov_b64 exec, s[50:51]
    ds_read_b128 v[100:103], v120 offset:16384
    ds_read_b128 v[104:107], v120 offset:16896
    s_mov_b64 exec, -1
    v_exp_f32 v38, v38
    v_exp_f32 v39, v39
    v_exp_f32 v40, v40
    v_mfma_f32_32x32x16_bf16 v[20:35], v[52:55], v[16:19], 0
    ds_read_b128 v[56:59], v118 offset:18432
    v_exp_f32 v41, v41
    v_exp_f32 v42, v42
    v_exp_f32 v43, v43
    v_exp_f32 v44, v44
    v_exp_f32 v45, v45
    v_smfmac_f32_32x32x32_bf16 v[0:15], v[108:111], v[36:43], v116
    v_exp_f32 v46, v46
    v_exp_f32 v47, v47
    v_exp_f32 v48, v48
    v_exp_f32 v49, v49
    v_exp_f32 v50, v50
    v_exp_f32 v51, v51
    s_setprio 2
    s_waitcnt lgkmcnt(0)
    v_exp_f32 v20, v20
    v_exp_f32 v21, v21
    v_smfmac_f32_32x32x32_bf16 v[0:15], v[112:115], v[44:51], v116
    s_mov_b64 exec, s[50:51]
    ds_read_b128 v[108:111], v120 offset:18432
    ds_read_b128 v[112:115], v120 offset:18944
    s_mov_b64 exec, -1
    v_exp_f32 v22, v22
    v_exp_f32 v23, v23
    v_exp_f32 v24, v24
    v_mfma_f32_32x32x16_bf16 v[36:51], v[56:59], v[16:19], 0
    ds_read_b128 v[52:55], v118 offset:20480
    v_exp_f32 v25, v25
    v_exp_f32 v26, v26
    v_exp_f32 v27, v27
    v_exp_f32 v28, v28
    v_exp_f32 v29, v29
    v_smfmac_f32_32x32x32_bf16 v[0:15], v[100:103], v[20:27], v116
    v_exp_f32 v30, v30
    v_exp_f32 v31, v31
    v_exp_f32 v32, v32
    v_exp_f32 v33, v33
    v_exp_f32 v34, v34
    v_exp_f32 v35, v35
    s_waitcnt lgkmcnt(0)
    v_exp_f32 v36, v36
    v_exp_f32 v37, v37
    v_smfmac_f32_32x32x32_bf16 v[0:15], v[104:107], v[28:35], v116
    s_mov_b64 exec, s[50:51]
    ds_read_b128 v[100:103], v120 offset:20480
    ds_read_b128 v[104:107], v120 offset:20992
    s_mov_b64 exec, -1
    v_exp_f32 v38, v38
    v_exp_f32 v39, v39
    v_exp_f32 v40, v40
    v_mfma_f32_32x32x16_bf16 v[20:35], v[52:55], v[16:19], 0
    ds_read_b128 v[56:59], v118 offset:22528
    v_exp_f32 v41, v41
    v_exp_f32 v42, v42
    v_exp_f32 v43, v43
    v_exp_f32 v44, v44
    v_exp_f32 v45, v45
    v_smfmac_f32_32x32x32_bf16 v[0:15], v[108:111], v[36:43], v116
    v_exp_f32 v46, v46
    v_exp_f32 v47, v47
    v_exp_f32 v48, v48
    v_exp_f32 v49, v49
    v_exp_f32 v50, v50
    v_exp_f32 v51, v51
    s_setprio 1
    s_waitcnt lgkmcnt(0)
    v_exp_f32 v20, v20
    v_exp_f32 v21, v21
    v_smfmac_f32_32x32x32_bf16 v[0:15], v[112:115], v[44:51], v116
    s_mov_b64 exec, s[50:51]
    ds_read_b128 v[108:111], v120 offset:22528
    ds_read_b128 v[112:115], v120 offset:23040
    s_mov_b64 exec, -1
    v_exp_f32 v22, v22
    v_exp_f32 v23, v23
    v_exp_f32 v24, v24
    v_mfma_f32_32x32x16_bf16 v[36:51], v[56:59], v[16:19], 0
    v_exp_f32 v25, v25
    v_exp_f32 v26, v26
    v_exp_f32 v27, v27
    v_exp_f32 v28, v28
    v_exp_f32 v29, v29
    v_smfmac_f32_32x32x32_bf16 v[0:15], v[100:103], v[20:27], v116
    v_exp_f32 v30, v30
    v_exp_f32 v31, v31
    v_exp_f32 v32, v32
    v_exp_f32 v33, v33
    v_exp_f32 v34, v34
    v_exp_f32 v35, v35
    s_setprio 0
    s_waitcnt lgkmcnt(0)
    v_exp_f32 v36, v36
    v_exp_f32 v37, v37
    v_smfmac_f32_32x32x32_bf16 v[0:15], v[104:107], v[28:35], v116
    v_exp_f32 v38, v38
    v_exp_f32 v39, v39
    v_exp_f32 v40, v40
    v_exp_f32 v41, v41
    v_exp_f32 v42, v42
    v_exp_f32 v43, v43
    v_exp_f32 v44, v44
    v_exp_f32 v45, v45
    v_smfmac_f32_32x32x32_bf16 v[0:15], v[108:111], v[36:43], v116
    v_exp_f32 v46, v46
    v_exp_f32 v47, v47
    v_exp_f32 v48, v48
    v_exp_f32 v49, v49
    v_exp_f32 v50, v50
    v_exp_f32 v51, v51
    s_nop 1
    v_smfmac_f32_32x32x32_bf16 v[0:15], v[112:115], v[44:51], v116
    s_setprio 3
    v_mov_b32 v122, s48
    v_mov_b32 v123, s49
    v_mov_b32 v125, 0x7f800000
    s_nop 7
    v_cmp_le_f32 s[52:53], v62, v8
    v_cmp_ge_f32 s[56:57], v63, v8
    v_maximum3_f32 v62, abs(v0), abs(v1), abs(v2)
    v_maximum3_f32 v62, abs(v3), abs(v4), v62
    v_maximum3_f32 v62, abs(v5), abs(v6), v62
    v_maximum3_f32 v62, abs(v7), v62, v62
    s_and_b64 s[52:53], s[52:53], s[56:57]
    v_cmp_gt_f32 vcc, v125, v62
    v_rcp_f32 v124, v8
    s_and_b64 s[52:53], s[52:53], vcc
    s_cmp_eq_u64 s[52:53], -1
    s_cbranch_scc0 L_fallback
L_finish:
    v_pk_mul_f32 v[0:1], v[0:1], v[124:125] op_sel_hi:[1,0]
    v_pk_mul_f32 v[2:3], v[2:3], v[124:125] op_sel_hi:[1,0]
    v_pk_mul_f32 v[4:5], v[4:5], v[124:125] op_sel_hi:[1,0]
    v_pk_mul_f32 v[6:7], v[6:7], v[124:125] op_sel_hi:[1,0]
    v_cvt_pk_bf16_f32 v12, v0, v1
    v_cvt_pk_bf16_f32 v13, v2, v3
    v_cvt_pk_bf16_f32 v14, v4, v5
    v_cvt_pk_bf16_f32 v15, v6, v7
    s_cmp_eq_u32 s27, 1
    s_cbranch_scc1 L_ostore_local
    buffer_store_dwordx4 v[12:15], v121, s[36:39], s58 offen sc1
    s_waitcnt vmcnt(0)
    s_mov_b64 exec, 1
    buffer_store_dwordx2 v[122:123], v60, s[36:39], s59 offen sc1
    s_mov_b64 exec, -1
    s_branch L_ostored
L_ostore_local:
    buffer_store_dwordx4 v[12:15], v121, s[36:39], s58 offen
    s_waitcnt vmcnt(0)
    s_mov_b64 exec, 1
    buffer_store_dwordx2 v[122:123], v60, s[36:39], s59 offen
    s_mov_b64 exec, -1
L_ostored:
    s_barrier
    s_cmp_ge_u32 s25, 8
    s_cbranch_scc1 L_done
    s_cmp_lt_u32 s25, 4
    s_cbranch_scc1 L_p3c
    s_and_b32 s56, s25, 3
    s_lshl_b32 s56, s56, 14
    s_barrier
    s_add_u32 m0, s56, 0
    s_add_u32 s53, s12, 16384
    buffer_load_dwordx4 v121, s[36:39], s53 offen sc1 lds
    s_add_u32 m0, s56, 1024
    s_add_u32 s53, s12, 17408
    buffer_load_dwordx4 v121, s[36:39], s53 offen sc1 lds
    s_add_u32 m0, s56, 2048
    s_add_u32 s53, s12, 18432
    buffer_load_dwordx4 v121, s[36:39], s53 offen sc1 lds
    s_add_u32 m0, s56, 3072
    s_add_u32 s53, s12, 19456
    buffer_load_dwordx4 v121, s[36:39], s53 offen sc1 lds
    s_add_u32 m0, s56, 4096
    s_add_u32 s53, s12, 20480
    buffer_load_dwordx4 v121, s[36:39], s53 offen sc1 lds
    s_add_u32 m0, s56, 5120
    s_add_u32 s53, s12, 21504
    buffer_load_dwordx4 v121, s[36:39], s53 offen sc1 lds
    s_add_u32 m0, s56, 6144
    s_add_u32 s53, s12, 22528
    buffer_load_dwordx4 v121, s[36:39], s53 offen sc1 lds
    s_add_u32 m0, s56, 7168
    s_add_u32 s53, s12, 23552
    buffer_load_dwordx4 v121, s[36:39], s53 offen sc1 lds
    s_add_u32 m0, s56, 8192
    s_add_u32 s53, s12, 24576
    buffer_load_dwordx4 v121, s[36:39], s53 offen sc1 lds
    s_add_u32 m0, s56, 9216
    s_add_u32 s53, s12, 25600
    buffer_load_dwordx4 v121, s[36:39], s53 offen sc1 lds
    s_add_u32 m0, s56, 10240
    s_add_u32 s53, s12, 26624
    buffer_load_dwordx4 v121, s[36:39], s53 offen sc1 lds
    s_add_u32 m0, s56, 11264
    s_add_u32 s53, s12, 27648
    buffer_load_dwordx4 v121, s[36:39], s53 offen sc1 lds
    s_add_u32 m0, s56, 12288
    s_add_u32 s53, s12, 28672
    buffer_load_dwordx4 v121, s[36:39], s53 offen sc1 lds
    s_add_u32 m0, s56, 13312
    s_add_u32 s53, s12, 29696
    buffer_load_dwordx4 v121, s[36:39], s53 offen sc1 lds
    s_add_u32 m0, s56, 14336
    s_add_u32 s53, s12, 30720
    buffer_load_dwordx4 v121, s[36:39], s53 offen sc1 lds
    s_add_u32 m0, s56, 15360
    s_add_u32 s53, s12, 31744
    buffer_load_dwordx4 v121, s[36:39], s53 offen sc1 lds
    s_waitcnt vmcnt(8)
    s_barrier
    s_waitcnt vmcnt(0)
    s_barrier
    s_endpgm
L_p3c:
    buffer_load_dwordx4 v[124:127], v121, s[36:39], s11 offen sc1
    v_lshrrev_b32 v6, 4, v121
    v_lshrrev_b32 v4, 5, v6
    v_bfe_u32 v5, v6, 2, 2
    v_lshl_add_u32 v4, v4, 2, v5
    v_lshlrev_b32 v4, 7, v4
    v_and_b32 v5, 1, v6
    v_lshl_add_u32 v4, v5, 6, v4
    v_bfe_u32 v5, v6, 4, 1
    v_lshl_add_u32 v4, v5, 4, v4
    v_bfe_u32 v5, v6, 3, 1
    v_lshl_add_u32 v4, v5, 5, v4
    v_bfe_u32 v5, v6, 1, 1
    v_lshl_add_u32 v4, v5, 3, v4
    v_add_u32 v120, 98304, v4
    v_xor_b32 v122, 32, v120
    s_lshl_b32 s56, s25, 14
    v_add_u32 v123, s56, v121
    ds_read_b64_tr_b16 v[96:97], v120 offset:0
    ds_read_b64_tr_b16 v[98:99], v120 offset:1024
    ds_read_b64_tr_b16 v[100:101], v122 offset:0
    ds_read_b64_tr_b16 v[102:103], v122 offset:1024
    ds_read_b64_tr_b16 v[104:105], v120 offset:2048
    ds_read_b64_tr_b16 v[106:107], v120 offset:3072
    ds_read_b64_tr_b16 v[108:109], v122 offset:2048
    ds_read_b64_tr_b16 v[110:111], v122 offset:3072
    s_mov_b32 s63, 262144
L_o_chk:
    s_waitcnt vmcnt(0)
    v_cmp_eq_u64 vcc, s[48:49], v[124:125]
    v_cmp_eq_u64 s[52:53], s[48:49], v[126:127]
    s_nop 1
    s_and_b64 vcc, vcc, s[52:53]
    s_cmp_eq_u64 vcc, -1
    s_cbranch_scc1 L_o_ok
    s_sleep 1
    buffer_load_dwordx4 v[124:127], v121, s[36:39], s11 offen sc1
    s_sub_u32 s63, s63, 1
    s_cmp_lg_u32 s63, 0
    s_cbranch_scc1 L_o_chk
    s_waitcnt vmcnt(0)
L_o_ok:
    s_add_u32 s53, s12, 0
    buffer_load_dwordx4 v[32:35], v121, s[36:39], s53 offen offset:0 sc1
    buffer_load_dwordx4 v[36:39], v121, s[36:39], s53 offen offset:1024 sc1
    buffer_load_dwordx4 v[40:43], v121, s[36:39], s53 offen offset:2048 sc1
    buffer_load_dwordx4 v[44:47], v121, s[36:39], s53 offen offset:3072 sc1
    s_add_u32 s53, s12, 4096
    buffer_load_dwordx4 v[48:51], v121, s[36:39], s53 offen offset:0 sc1
    buffer_load_dwordx4 v[52:55], v121, s[36:39], s53 offen offset:1024 sc1
    buffer_load_dwordx4 v[56:59], v121, s[36:39], s53 offen offset:2048 sc1
    buffer_load_dwordx4 v[60:63], v121, s[36:39], s53 offen offset:3072 sc1
    s_add_u32 s53, s12, 8192
    buffer_load_dwordx4 v[64:67], v121, s[36:39], s53 offen offset:0 sc1
    buffer_load_dwordx4 v[68:71], v121, s[36:39], s53 offen offset:1024 sc1
    buffer_load_dwordx4 v[72:75], v121, s[36:39], s53 offen offset:2048 sc1
    buffer_load_dwordx4 v[76:79], v121, s[36:39], s53 offen offset:3072 sc1
    s_add_u32 s53, s12, 12288
    buffer_load_dwordx4 v[80:83], v121, s[36:39], s53 offen offset:0 sc1
    buffer_load_dwordx4 v[84:87], v121, s[36:39], s53 offen offset:1024 sc1
    buffer_load_dwordx4 v[88:91], v121, s[36:39], s53 offen offset:2048 sc1
    buffer_load_dwordx4 v[92:95], v121, s[36:39], s53 offen offset:3072 sc1
    s_barrier
    s_waitcnt vmcnt(15) lgkmcnt(4)
    v_mfma_f32_32x32x16_bf16 v[0:15], v[96:99], v[32:35], 0
    ds_read_b64_tr_b16 v[112:113], v120 offset:4096
    ds_read_b64_tr_b16 v[114:115], v120 offset:5120
    v_mfma_f32_32x32x16_bf16 v[16:31], v[100:103], v[32:35], 0
    ds_read_b64_tr_b16 v[116:117], v122 offset:4096
    ds_read_b64_tr_b16 v[118:119], v122 offset:5120
    s_waitcnt vmcnt(14) lgkmcnt(4)
    v_mfma_f32_32x32x16_bf16 v[0:15], v[104:107], v[36:39], v[0:15]
    ds_read_b64_tr_b16 v[96:97], v120 offset:6144
    ds_read_b64_tr_b16 v[98:99], v120 offset:7168
    v_mfma_f32_32x32x16_bf16 v[16:31], v[108:111], v[36:39], v[16:31]
    ds_read_b64_tr_b16 v[100:101], v122 offset:6144
    ds_read_b64_tr_b16 v[102:103], v122 offset:7168
    s_waitcnt vmcnt(13) lgkmcnt(4)
    v_mfma_f32_32x32x16_bf16 v[0:15], v[112:115], v[40:43], v[0:15]
    ds_read_b64_tr_b16 v[104:105], v120 offset:8192
    ds_read_b64_tr_b16 v[106:107], v120 offset:9216
    v_mfma_f32_32x32x16_bf16 v[16:31], v[116:119], v[40:43], v[16:31]
    ds_read_b64_tr_b16 v[108:109], v122 offset:8192
    ds_read_b64_tr_b16 v[110:111], v122 offset:9216
    s_waitcnt vmcnt(12) lgkmcnt(4)
    v_mfma_f32_32x32x16_bf16 v[0:15], v[96:99], v[44:47], v[0:15]
    ds_read_b64_tr_b16 v[112:113], v120 offset:10240
    ds_read_b64_tr_b16 v[114:115], v120 offset:11264
    v_mfma_f32_32x32x16_bf16 v[16:31], v[100:103], v[44:47], v[16:31]
    ds_read_b64_tr_b16 v[116:117], v122 offset:10240
    ds_read_b64_tr_b16 v[118:119], v122 offset:11264
    s_waitcnt vmcnt(11) lgkmcnt(4)
    v_mfma_f32_32x32x16_bf16 v[0:15], v[104:107], v[48:51], v[0:15]
    ds_read_b64_tr_b16 v[96:97], v120 offset:12288
    ds_read_b64_tr_b16 v[98:99], v120 offset:13312
    v_mfma_f32_32x32x16_bf16 v[16:31], v[108:111], v[48:51], v[16:31]
    ds_read_b64_tr_b16 v[100:101], v122 offset:12288
    ds_read_b64_tr_b16 v[102:103], v122 offset:13312
    s_waitcnt vmcnt(10) lgkmcnt(4)
    v_mfma_f32_32x32x16_bf16 v[0:15], v[112:115], v[52:55], v[0:15]
    ds_read_b64_tr_b16 v[104:105], v120 offset:14336
    ds_read_b64_tr_b16 v[106:107], v120 offset:15360
    v_mfma_f32_32x32x16_bf16 v[16:31], v[116:119], v[52:55], v[16:31]
    ds_read_b64_tr_b16 v[108:109], v122 offset:14336
    ds_read_b64_tr_b16 v[110:111], v122 offset:15360
    s_waitcnt vmcnt(9) lgkmcnt(4)
    v_mfma_f32_32x32x16_bf16 v[0:15], v[96:99], v[56:59], v[0:15]
    ds_read_b64_tr_b16 v[112:113], v120 offset:16384
    ds_read_b64_tr_b16 v[114:115], v120 offset:17408
    v_mfma_f32_32x32x16_bf16 v[16:31], v[100:103], v[56:59], v[16:31]
    ds_read_b64_tr_b16 v[116:117], v122 offset:16384
    ds_read_b64_tr_b16 v[118:119], v122 offset:17408
    s_waitcnt vmcnt(8) lgkmcnt(4)
    v_mfma_f32_32x32x16_bf16 v[0:15], v[104:107], v[60:63], v[0:15]
    ds_read_b64_tr_b16 v[96:97], v120 offset:18432
    ds_read_b64_tr_b16 v[98:99], v120 offset:19456
    v_mfma_f32_32x32x16_bf16 v[16:31], v[108:111], v[60:63], v[16:31]
    ds_read_b64_tr_b16 v[100:101], v122 offset:18432
    ds_read_b64_tr_b16 v[102:103], v122 offset:19456
    s_waitcnt vmcnt(7) lgkmcnt(4)
    v_mfma_f32_32x32x16_bf16 v[0:15], v[112:115], v[64:67], v[0:15]
    ds_read_b64_tr_b16 v[104:105], v120 offset:20480
    ds_read_b64_tr_b16 v[106:107], v120 offset:21504
    v_mfma_f32_32x32x16_bf16 v[16:31], v[116:119], v[64:67], v[16:31]
    ds_read_b64_tr_b16 v[108:109], v122 offset:20480
    ds_read_b64_tr_b16 v[110:111], v122 offset:21504
    s_waitcnt vmcnt(6) lgkmcnt(4)
    v_mfma_f32_32x32x16_bf16 v[0:15], v[96:99], v[68:71], v[0:15]
    ds_read_b64_tr_b16 v[112:113], v120 offset:22528
    ds_read_b64_tr_b16 v[114:115], v120 offset:23552
    v_mfma_f32_32x32x16_bf16 v[16:31], v[100:103], v[68:71], v[16:31]
    ds_read_b64_tr_b16 v[116:117], v122 offset:22528
    ds_read_b64_tr_b16 v[118:119], v122 offset:23552
    s_waitcnt vmcnt(5) lgkmcnt(4)
    v_mfma_f32_32x32x16_bf16 v[0:15], v[104:107], v[72:75], v[0:15]
    ds_read_b64_tr_b16 v[96:97], v120 offset:24576
    ds_read_b64_tr_b16 v[98:99], v120 offset:25600
    v_mfma_f32_32x32x16_bf16 v[16:31], v[108:111], v[72:75], v[16:31]
    ds_read_b64_tr_b16 v[100:101], v122 offset:24576
    ds_read_b64_tr_b16 v[102:103], v122 offset:25600
    s_waitcnt vmcnt(4) lgkmcnt(4)
    v_mfma_f32_32x32x16_bf16 v[0:15], v[112:115], v[76:79], v[0:15]
    ds_read_b64_tr_b16 v[104:105], v120 offset:26624
    ds_read_b64_tr_b16 v[106:107], v120 offset:27648
    v_mfma_f32_32x32x16_bf16 v[16:31], v[116:119], v[76:79], v[16:31]
    ds_read_b64_tr_b16 v[108:109], v122 offset:26624
    ds_read_b64_tr_b16 v[110:111], v122 offset:27648
    s_waitcnt vmcnt(3) lgkmcnt(4)
    v_mfma_f32_32x32x16_bf16 v[0:15], v[96:99], v[80:83], v[0:15]
    ds_read_b64_tr_b16 v[112:113], v120 offset:28672
    ds_read_b64_tr_b16 v[114:115], v120 offset:29696
    v_mfma_f32_32x32x16_bf16 v[16:31], v[100:103], v[80:83], v[16:31]
    ds_read_b64_tr_b16 v[116:117], v122 offset:28672
    ds_read_b64_tr_b16 v[118:119], v122 offset:29696
    s_waitcnt vmcnt(2) lgkmcnt(4)
    v_mfma_f32_32x32x16_bf16 v[0:15], v[104:107], v[84:87], v[0:15]
    ds_read_b64_tr_b16 v[96:97], v120 offset:30720
    ds_read_b64_tr_b16 v[98:99], v120 offset:31744
    v_mfma_f32_32x32x16_bf16 v[16:31], v[108:111], v[84:87], v[16:31]
    ds_read_b64_tr_b16 v[100:101], v122 offset:30720
    ds_read_b64_tr_b16 v[102:103], v122 offset:31744
    s_waitcnt vmcnt(1) lgkmcnt(4)
    v_mfma_f32_32x32x16_bf16 v[0:15], v[112:115], v[88:91], v[0:15]
    ds_read_b64_tr_b16 v[104:105], v120 offset:32768
    ds_read_b64_tr_b16 v[106:107], v120 offset:33792
    v_mfma_f32_32x32x16_bf16 v[16:31], v[116:119], v[88:91], v[16:31]
    ds_read_b64_tr_b16 v[108:109], v122 offset:32768
    ds_read_b64_tr_b16 v[110:111], v122 offset:33792
    s_waitcnt vmcnt(0) lgkmcnt(4)
    v_mfma_f32_32x32x16_bf16 v[0:15], v[96:99], v[92:95], v[0:15]
    ds_read_b64_tr_b16 v[112:113], v120 offset:34816
    ds_read_b64_tr_b16 v[114:115], v120 offset:35840
    v_mfma_f32_32x32x16_bf16 v[16:31], v[100:103], v[92:95], v[16:31]
    ds_read_b64_tr_b16 v[116:117], v122 offset:34816
    ds_read_b64_tr_b16 v[118:119], v122 offset:35840
    s_barrier
    ds_read_b128 v[32:35], v123 offset:0
    ds_read_b128 v[36:39], v123 offset:1024
    s_waitcnt lgkmcnt(1)
    v_mfma_f32_32x32x16_bf16 v[0:15], v[104:107], v[32:35], v[0:15]
    ds_read_b64_tr_b16 v[96:97], v120 offset:36864
    ds_read_b64_tr_b16 v[98:99], v120 offset:37888
    ds_read_b128 v[40:43], v123 offset:2048
    v_mfma_f32_32x32x16_bf16 v[16:31], v[108:111], v[32:35], v[16:31]
    ds_read_b64_tr_b16 v[100:101], v122 offset:36864
    ds_read_b64_tr_b16 v[102:103], v122 offset:37888
    s_waitcnt lgkmcnt(5)
    v_mfma_f32_32x32x16_bf16 v[0:15], v[112:115], v[36:39], v[0:15]
    ds_read_b64_tr_b16 v[104:105], v120 offset:38912
    ds_read_b64_tr_b16 v[106:107], v120 offset:39936
    ds_read_b128 v[44:47], v123 offset:3072
    v_mfma_f32_32x32x16_bf16 v[16:31], v[116:119], v[36:39], v[16:31]
    ds_read_b64_tr_b16 v[108:109], v122 offset:38912
    ds_read_b64_tr_b16 v[110:111], v122 offset:39936
    s_waitcnt lgkmcnt(5)
    v_mfma_f32_32x32x16_bf16 v[0:15], v[96:99], v[40:43], v[0:15]
    ds_read_b64_tr_b16 v[112:113], v120 offset:40960
    ds_read_b64_tr_b16 v[114:115], v120 offset:41984
    ds_read_b128 v[48:51], v123 offset:4096
    v_mfma_f32_32x32x16_bf16 v[16:31], v[100:103], v[40:43], v[16:31]
    ds_read_b64_tr_b16 v[116:117], v122 offset:40960
    ds_read_b64_tr_b16 v[118:119], v122 offset:41984
    s_waitcnt lgkmcnt(5)
    v_mfma_f32_32x32x16_bf16 v[0:15], v[104:107], v[44:47], v[0:15]
    ds_read_b64_tr_b16 v[96:97], v120 offset:43008
    ds_read_b64_tr_b16 v[98:99], v120 offset:44032
    ds_read_b128 v[52:55], v123 offset:5120
    v_mfma_f32_32x32x16_bf16 v[16:31], v[108:111], v[44:47], v[16:31]
    ds_read_b64_tr_b16 v[100:101], v122 offset:43008
    ds_read_b64_tr_b16 v[102:103], v122 offset:44032
    s_waitcnt lgkmcnt(5)
    v_mfma_f32_32x32x16_bf16 v[0:15], v[112:115], v[48:51], v[0:15]
    ds_read_b64_tr_b16 v[104:105], v120 offset:45056
    ds_read_b64_tr_b16 v[106:107], v120 offset:46080
    ds_read_b128 v[56:59], v123 offset:6144
    v_mfma_f32_32x32x16_bf16 v[16:31], v[116:119], v[48:51], v[16:31]
    ds_read_b64_tr_b16 v[108:109], v122 offset:45056
    ds_read_b64_tr_b16 v[110:111], v122 offset:46080
    s_waitcnt lgkmcnt(5)
    v_mfma_f32_32x32x16_bf16 v[0:15], v[96:99], v[52:55], v[0:15]
    ds_read_b64_tr_b16 v[112:113], v120 offset:47104
    ds_read_b64_tr_b16 v[114:115], v120 offset:48128
    ds_read_b128 v[60:63], v123 offset:7168
    v_mfma_f32_32x32x16_bf16 v[16:31], v[100:103], v[52:55], v[16:31]
    ds_read_b64_tr_b16 v[116:117], v122 offset:47104
    ds_read_b64_tr_b16 v[118:119], v122 offset:48128
    s_waitcnt lgkmcnt(5)
    v_mfma_f32_32x32x16_bf16 v[0:15], v[104:107], v[56:59], v[0:15]
    ds_read_b64_tr_b16 v[96:97], v120 offset:49152
    ds_read_b64_tr_b16 v[98:99], v120 offset:50176
    v_mfma_f32_32x32x16_bf16 v[16:31], v[108:111], v[56:59], v[16:31]
    ds_read_b64_tr_b16 v[100:101], v122 offset:49152
    ds_read_b64_tr_b16 v[102:103], v122 offset:50176
    s_waitcnt lgkmcnt(4)
    v_mfma_f32_32x32x16_bf16 v[0:15], v[112:115], v[60:63], v[0:15]
    ds_read_b64_tr_b16 v[104:105], v120 offset:51200
    ds_read_b64_tr_b16 v[106:107], v120 offset:52224
    v_mfma_f32_32x32x16_bf16 v[16:31], v[116:119], v[60:63], v[16:31]
    ds_read_b64_tr_b16 v[108:109], v122 offset:51200
    ds_read_b64_tr_b16 v[110:111], v122 offset:52224
    s_barrier
    ds_read_b128 v[64:67], v123 offset:8192
    ds_read_b128 v[68:71], v123 offset:9216
    s_waitcnt lgkmcnt(1)
    v_mfma_f32_32x32x16_bf16 v[0:15], v[96:99], v[64:67], v[0:15]
    ds_read_b64_tr_b16 v[112:113], v120 offset:53248
    ds_read_b64_tr_b16 v[114:115], v120 offset:54272
    ds_read_b128 v[72:75], v123 offset:10240
    v_mfma_f32_32x32x16_bf16 v[16:31], v[100:103], v[64:67], v[16:31]
    ds_read_b64_tr_b16 v[116:117], v122 offset:53248
    ds_read_b64_tr_b16 v[118:119], v122 offset:54272
    s_waitcnt lgkmcnt(5)
    v_mfma_f32_32x32x16_bf16 v[0:15], v[104:107], v[68:71], v[0:15]
    ds_read_b64_tr_b16 v[96:97], v120 offset:55296
    ds_read_b64_tr_b16 v[98:99], v120 offset:56320
    ds_read_b128 v[76:79], v123 offset:11264
    v_mfma_f32_32x32x16_bf16 v[16:31], v[108:111], v[68:71], v[16:31]
    ds_read_b64_tr_b16 v[100:101], v122 offset:55296
    ds_read_b64_tr_b16 v[102:103], v122 offset:56320
    s_waitcnt lgkmcnt(5)
    v_mfma_f32_32x32x16_bf16 v[0:15], v[112:115], v[72:75], v[0:15]
    ds_read_b64_tr_b16 v[104:105], v120 offset:57344
    ds_read_b64_tr_b16 v[106:107], v120 offset:58368
    ds_read_b128 v[80:83], v123 offset:12288
    v_mfma_f32_32x32x16_bf16 v[16:31], v[116:119], v[72:75], v[16:31]
    ds_read_b64_tr_b16 v[108:109], v122 offset:57344
    ds_read_b64_tr_b16 v[110:111], v122 offset:58368
    s_waitcnt lgkmcnt(5)
    v_mfma_f32_32x32x16_bf16 v[0:15], v[96:99], v[76:79], v[0:15]
    ds_read_b64_tr_b16 v[112:113], v120 offset:59392
    ds_read_b64_tr_b16 v[114:115], v120 offset:60416
    ds_read_b128 v[84:87], v123 offset:13312
    v_mfma_f32_32x32x16_bf16 v[16:31], v[100:103], v[76:79], v[16:31]
    ds_read_b64_tr_b16 v[116:117], v122 offset:59392
    ds_read_b64_tr_b16 v[118:119], v122 offset:60416
    s_waitcnt lgkmcnt(5)
    v_mfma_f32_32x32x16_bf16 v[0:15], v[104:107], v[80:83], v[0:15]
    ds_read_b64_tr_b16 v[96:97], v120 offset:61440
    ds_read_b64_tr_b16 v[98:99], v120 offset:62464
    ds_read_b128 v[88:91], v123 offset:14336
    v_mfma_f32_32x32x16_bf16 v[16:31], v[108:111], v[80:83], v[16:31]
    ds_read_b64_tr_b16 v[100:101], v122 offset:61440
    ds_read_b64_tr_b16 v[102:103], v122 offset:62464
    s_waitcnt lgkmcnt(5)
    v_mfma_f32_32x32x16_bf16 v[0:15], v[112:115], v[84:87], v[0:15]
    ds_read_b64_tr_b16 v[104:105], v120 offset:63488
    ds_read_b64_tr_b16 v[106:107], v120 offset:64512
    ds_read_b128 v[92:95], v123 offset:15360
    v_mfma_f32_32x32x16_bf16 v[16:31], v[116:119], v[84:87], v[16:31]
    ds_read_b64_tr_b16 v[108:109], v122 offset:63488
    ds_read_b64_tr_b16 v[110:111], v122 offset:64512
    s_waitcnt lgkmcnt(5)
    v_mfma_f32_32x32x16_bf16 v[0:15], v[96:99], v[88:91], v[0:15]
    v_mfma_f32_32x32x16_bf16 v[16:31], v[100:103], v[88:91], v[16:31]
    s_waitcnt lgkmcnt(0)
    v_mfma_f32_32x32x16_bf16 v[0:15], v[104:107], v[92:95], v[0:15]
    v_mfma_f32_32x32x16_bf16 v[16:31], v[108:111], v[92:95], v[16:31]
    v_lshrrev_b32 v118, 4, v121
    v_and_b32 v119, 31, v118
    v_lshrrev_b32 v117, 5, v118
    v_lshlrev_b32 v117, 2, v117
    v_and_b32 v120, 7, v118
    v_xor_b32 v117, v117, v120
    v_lshlrev_b32 v117, 4, v117
    v_lshl_add_u32 v119, v119, 7, v117
    s_mov_b32 s52, s56
    v_add_u32 v119, s52, v119
    v_lshrrev_b32 v117, 3, v118
    v_xor_b32 v116, v117, v120
    v_lshlrev_b32 v116, 4, v116
    v_lshl_add_u32 v116, v117, 7, v116
    v_add_u32 v116, s52, v116
    v_lshlrev_b32 v120, 4, v120
    v_lshl_add_u32 v120, v117, 11, v120
    v_cvt_pk_bf16_f32 v32, v0, v1
    v_cvt_pk_bf16_f32 v33, v2, v3
    v_cvt_pk_bf16_f32 v34, v4, v5
    v_cvt_pk_bf16_f32 v35, v6, v7
    ds_write_b128 v119, v[32:35]
    v_cvt_pk_bf16_f32 v36, v8, v9
    v_cvt_pk_bf16_f32 v37, v10, v11
    v_cvt_pk_bf16_f32 v38, v12, v13
    v_cvt_pk_bf16_f32 v39, v14, v15
    v_xor_b32 v117, 16, v119
    ds_write_b128 v117, v[36:39]
    v_cvt_pk_bf16_f32 v40, v16, v17
    v_cvt_pk_bf16_f32 v41, v18, v19
    v_cvt_pk_bf16_f32 v42, v20, v21
    v_cvt_pk_bf16_f32 v43, v22, v23
    v_xor_b32 v117, 32, v119
    ds_write_b128 v117, v[40:43]
    v_cvt_pk_bf16_f32 v44, v24, v25
    v_cvt_pk_bf16_f32 v45, v26, v27
    v_cvt_pk_bf16_f32 v46, v28, v29
    v_cvt_pk_bf16_f32 v47, v30, v31
    v_xor_b32 v117, 48, v119
    ds_write_b128 v117, v[44:47]
    s_waitcnt lgkmcnt(0)
    ds_read_b128 v[48:51], v116 offset:0
    ds_read_b128 v[52:55], v116 offset:1024
    ds_read_b128 v[56:59], v116 offset:2048
    ds_read_b128 v[60:63], v116 offset:3072
    s_add_u32 s53, s13, 0
    s_waitcnt lgkmcnt(3)
    buffer_store_dwordx4 v[48:51], v120, s[44:47], s53 offen
    s_add_u32 s53, s13, 16384
    s_waitcnt lgkmcnt(2)
    buffer_store_dwordx4 v[52:55], v120, s[44:47], s53 offen
    s_add_u32 s53, s13, 32768
    s_waitcnt lgkmcnt(1)
    buffer_store_dwordx4 v[56:59], v120, s[44:47], s53 offen
    s_add_u32 s53, s13, 49152
    s_waitcnt lgkmcnt(0)
    buffer_store_dwordx4 v[60:63], v120, s[44:47], s53 offen
L_done:
    s_endpgm
L_fallback:
    s_lshr_b32 s52, s25, 3
    s_lshl_b32 s52, s52, 13
    s_add_u32 s52, s52, s54
    v_mov_b32 v124, 0xff800000
    s_mov_b32 s63, 0
    v_sub_u32 v125, v119, v117
    v_add_u32 v125, v125, v121
L_fb1:
    s_lshr_b32 s53, s63, 2
    s_lshl_b32 s53, s53, 14
    s_and_b32 s56, s63, 3
    s_lshl_b32 s56, s56, 11
    s_add_u32 s53, s53, s56
    s_add_u32 s53, s53, s52
    buffer_load_dwordx4 v[52:55], v121, s[36:39], s53 offen sc1
    s_waitcnt vmcnt(0)
    v_mfma_f32_32x32x16_bf16 v[20:35], v[52:55], v[16:19], 0
    s_nop 15
    v_max3_f32 v124, v20, v21, v124
    v_max3_f32 v124, v22, v23, v124
    v_max3_f32 v124, v24, v25, v124
    v_max3_f32 v124, v26, v27, v124
    v_max3_f32 v124, v28, v29, v124
    v_max3_f32 v124, v30, v31, v124
    v_max3_f32 v124, v32, v33, v124
    v_max3_f32 v124, v34, v35, v124
    s_add_u32 s63, s63, 1
    s_cmp_lg_u32 s63, 64
    s_cbranch_scc1 L_fb1
    v_mov_b32 v122, v124
    s_nop 1
    v_permlane32_swap_b32 v124, v122
    s_nop 1
    v_max_f32 v124, v124, v122
    v_sub_f32 v124, 0, v124
    v_mov_b32 v80, v124
    v_mov_b32 v81, v124
    v_mov_b32 v82, v124
    v_mov_b32 v83, v124
    v_mov_b32 v84, v124
    v_mov_b32 v85, v124
    v_mov_b32 v86, v124
    v_mov_b32 v87, v124
    v_mov_b32 v88, v124
    v_mov_b32 v89, v124
    v_mov_b32 v90, v124
    v_mov_b32 v91, v124
    v_mov_b32 v92, v124
    v_mov_b32 v93, v124
    v_mov_b32 v94, v124
    v_mov_b32 v95, v124
    v_mov_b32 v0, 0
    v_mov_b32 v1, 0
    v_mov_b32 v2, 0
    v_mov_b32 v3, 0
    v_mov_b32 v4, 0
    v_mov_b32 v5, 0
    v_mov_b32 v6, 0
    v_mov_b32 v7, 0
    v_mov_b32 v8, 0
    v_mov_b32 v9, 0
    v_mov_b32 v10, 0
    v_mov_b32 v11, 0
    v_mov_b32 v12, 0
    v_mov_b32 v13, 0
    v_mov_b32 v14, 0
    v_mov_b32 v15, 0
    s_mov_b32 s63, 0
L_fb2:
    s_lshr_b32 s53, s63, 2
    s_lshl_b32 s53, s53, 14
    s_and_b32 s56, s63, 3
    s_lshl_b32 s56, s56, 11
    s_add_u32 s53, s53, s56
    s_add_u32 s53, s53, s52
    buffer_load_dwordx4 v[52:55], v121, s[36:39], s53 offen sc1
    s_mov_b64 exec, s[50:51]
    buffer_load_dwordx4 v[100:103], v125, s[36:39], s53 offen sc1
    buffer_load_dwordx4 v[104:107], v125, s[36:39], s53 offen offset:512 sc1
    s_mov_b64 exec, -1
    s_waitcnt vmcnt(0)
    v_mfma_f32_32x32x16_bf16 v[20:35], v[52:55], v[16:19], v[80:95]
    s_nop 15
    v_exp_f32 v20, v20
    v_exp_f32 v21, v21
    v_exp_f32 v22, v22
    v_exp_f32 v23, v23
    v_exp_f32 v24, v24
    v_exp_f32 v25, v25
    v_exp_f32 v26, v26
    v_exp_f32 v27, v27
    v_exp_f32 v28, v28
    v_exp_f32 v29, v29
    v_exp_f32 v30, v30
    v_exp_f32 v31, v31
    v_exp_f32 v32, v32
    v_exp_f32 v33, v33
    v_exp_f32 v34, v34
    v_exp_f32 v35, v35
    s_nop 1
    v_smfmac_f32_32x32x32_bf16 v[0:15], v[100:103], v[20:27], v116
    v_smfmac_f32_32x32x32_bf16 v[0:15], v[104:107], v[28:35], v116
    s_add_u32 s63, s63, 1
    s_cmp_lg_u32 s63, 64
    s_cbranch_scc1 L_fb2
    s_nop 15
    v_rcp_f32 v124, v8
    v_mov_b32 v122, s48
    v_mov_b32 v123, s49
    s_branch L_finish
L_code_end:
.section .rodata,"a"
.p2align 6
.amdhsa_kernel concat_heads__mha_block__mha_block__prompt_kernel
  .amdhsa_next_free_vgpr 128
  .amdhsa_next_free_sgpr 68
  .amdhsa_accum_offset 128
  .amdhsa_group_segment_fixed_size 0
  .amdhsa_kernarg_size 72
  .amdhsa_user_sgpr_count 2
  .amdhsa_user_sgpr_kernarg_segment_ptr 1
  .amdhsa_system_sgpr_workgroup_id_x 1
.end_amdhsa_kernel
```
